```python
import torch

def _softmax(x, axis=-1):
    return torch.softmax(x, dim=axis)
def _gelu(x):
    return torch.nn.functional.gelu(x, approximate="tanh")
def _silu(x):
    return torch.nn.functional.silu(x)
def _sigmoid(x):
    return torch.sigmoid(x)
def _layernorm(x, axis=-1, eps=1e-5):
    m = x.mean(dim=axis, keepdim=True)
    v = x.var(dim=axis, keepdim=True, unbiased=False)
    return (x - m) / torch.sqrt(v + eps)
def _scatter_add(tgt, idx, src, axis=0):
    return tgt.clone().index_add_(axis, idx, src)
def _segment_sum(src, seg, n):
    out = torch.zeros((n,) + src.shape[1:], dtype=src.dtype)
    return out.index_add_(0, seg, src)
def _pad(x, pw):
    flat = tuple(v for pair in reversed(pw) for v in pair)
    return torch.nn.functional.pad(x, flat)

kernel_name = 'gated_mix__sliding_block__dense_activation_relu__prompt'

def setup_inputs():

    _w = (lambda a: (lambda t: t.to(torch.bfloat16) if t.is_floating_point() else t)(torch.as_tensor(a)))
    def _A_setup():
        B, S, D = 1, 2048, 512
        return {
            "x": _w((lambda *s: torch.randn(*s, dtype=torch.bfloat16) * 0.05)(B, S, D)),
            "wqkv": _w((lambda *s: torch.randn(*s, dtype=torch.bfloat16) * 0.8)(D, 3 * D)),
            "wo": _w((lambda *s: torch.randn(*s, dtype=torch.bfloat16) * 0.05)(D, D)),
        }
    _A_in = _A_setup()

    def _B_setup():
        B, S, D, Dff = 1, 2048, 512, 1376
        return {
            "x": _w((lambda *s: torch.randn(*s, dtype=torch.bfloat16) * 0.05)(B, S, D)),
            "w1": _w((lambda *s: torch.randn(*s, dtype=torch.bfloat16) * 0.05)(D, Dff)),
            "w2": _w((lambda *s: torch.randn(*s, dtype=torch.bfloat16) * 0.05)(Dff, D)),
        }
    _B_in = _B_setup()

    return {
        "A_x": _A_in["x"],
        "A_wqkv": _A_in["wqkv"],
        "A_wo": _A_in["wo"],
        "B_x": _B_in["x"],
        "B_w1": _B_in["w1"],
        "B_w2": _B_in["w2"],
        "gate_w": _w((lambda *s: torch.randn(*s, dtype=torch.bfloat16) * 0.05)(512) * 16.0),
    }

def reference(A_x, A_wqkv, A_wo, B_x, B_w1, B_w2, gate_w):
    def _A_ref(x, wqkv, wo):
        B, S, D = x.shape
        H = 32; Dh = D // H; W = 256
        qkv = (lambda x, *d: x.permute(*d))((x @ wqkv).reshape(B, S, 3, H, Dh), 2, 0, 3, 1, 4)
        q, k, v = qkv[0], qkv[1], qkv[2]
        scores = torch.einsum("bhqd,bhkd->bhqk", q, k) * (Dh ** -0.5)
        idx = torch.arange(S)
        mask = (idx[:, None] - idx[None, :] >= 0) & (idx[:, None] - idx[None, :] < W)
        scores = torch.where(mask[None, None], scores, -1e9)
        p = _softmax(scores, axis=-1)
        o = torch.einsum("bhqk,bhkd->bhqd", p, v)
        return (lambda x, *d: x.permute(*d))(o, 0, 2, 1, 3).reshape(B, S, D) @ wo

    def _B_ref(x, w1, w2):
        h = torch.einsum("bsd,df->bsf", x, w1)
        zero = torch.zeros_like(h)
        h = torch.maximum(h, zero)
        return torch.einsum("bsf,fd->bsd", h, w2)

    x = A_x
    g = _sigmoid((x * gate_w).sum(-1, keepdims=True))
    a = _A_ref(x, A_wqkv, A_wo)
    b = _B_ref(x, B_w1, B_w2)
    return g * a + (1 - g) * b
```

```asm
; @launch grid=(256,1,1) block=(512,1,1) lds=163840
.amdgcn_target "amdgcn-amd-amdhsa--gfx950"
.text
.globl gated_mix__sliding_block__dense_activation_relu__prompt_kernel
.p2align 8
.type gated_mix__sliding_block__dense_activation_relu__prompt_kernel,@function
gated_mix__sliding_block__dense_activation_relu__prompt_kernel:
    s_cmp_ge_u32 s2, 256
    s_cbranch_scc1 L_exit
    s_load_dwordx4 s[8:11], s[0:1], 0
    s_load_dwordx2 s[24:25], s[0:1], 16
    s_load_dwordx4 s[16:19], s[0:1], 32
    s_load_dwordx4 s[36:39], s[0:1], 48
    s_load_dwordx4 s[40:43], s[0:1], 64
    s_memrealtime s[58:59]
    v_and_b32 v1, 63, v0
    v_lshrrev_b32 v15, 6, v0
    v_lshlrev_b32 v2, 4, v1
    v_readfirstlane_b32 s44, v15
    s_and_b32 s54, s2, 7
    s_lshr_b32 s55, s2, 3
    s_and_b32 s45, s54, 1
    s_lshl_b32 s45, s45, 3
    s_and_b32 s60, s55, 7
    s_add_u32 s45, s45, s60
    s_lshr_b32 s46, s54, 1
    s_lshl_b32 s46, s46, 2
    s_lshr_b32 s60, s55, 3
    s_add_u32 s46, s46, s60
    s_lshr_b32 s47, s46, 1
    s_and_b32 s48, s46, 1
    s_lshl_b32 s51, s54, 2
    s_and_b32 s60, s55, 3
    s_add_u32 s51, s51, s60
    s_lshr_b32 s52, s55, 2
    s_and_b32 s49, s44, 3
    s_lshr_b32 s50, s44, 2
    s_lshl_b32 s76, s44, 11
    s_lshl_b32 s66, s44, 12
    s_lshl_b32 s53, s45, 17
    s_lshl_b32 s60, s44, 14
    s_add_u32 s53, s53, s60
    v_lshrrev_b32 v15, 4, v1
    v_and_b32 v16, 15, v1
    v_xor_b32 v16, v16, v15
    v_lshlrev_b32 v15, 10, v15
    v_xor_b32 v18, 0, v16
    v_lshl_add_u32 v3, v18, 4, v15
    v_xor_b32 v18, 4, v16
    v_lshl_add_u32 v4, v18, 4, v15
    v_xor_b32 v18, 8, v16
    v_lshl_add_u32 v5, v18, 4, v15
    v_xor_b32 v18, 12, v16
    v_lshl_add_u32 v6, v18, 4, v15
    v_lshrrev_b32 v15, 3, v1
    v_and_b32 v16, 7, v1
    v_lshrrev_b32 v18, 2, v1
    v_and_b32 v18, 4, v18
    v_xor_b32 v16, v16, v18
    v_lshlrev_b32 v16, 4, v16
    s_movk_i32 s60, 3072
    v_mad_u32_u24 v7, v15, s60, v16
    v_lshl_add_u32 v14, v15, 10, v16
    s_mul_i32 s57, s44, 49152
    s_lshl_b32 s60, s47, 7
    s_add_u32 s57, s57, s60
    s_lshl_b32 s60, s48, 10
    s_add_u32 s57, s57, s60
    s_add_u32 s57, s57, 1024
    s_lshl_b32 s60, s47, 1
    s_add_u32 s60, s60, s50
    s_lshl_b32 s60, s60, 6
    s_lshl_b32 s61, s45, 2
    s_add_u32 s61, s61, s49
    s_add_u32 s60, s60, s61
    s_lshl_b32 s62, s60, 11
    s_lshl_b32 s60, s48, 21
    s_add_u32 s62, s62, s60
    s_add_u32 s62, s62, 2097152
    s_mul_i32 s61, s61, 88064
    s_add_u32 s61, s61, 8388608
    s_mul_i32 s60, s46, 3
    s_lshl_b32 s63, s60, 11
    s_add_u32 s63, s63, s61
    s_cmp_ge_u32 s60, 43
    s_cselect_b32 s63, 1073741824, s63
    s_cmp_eq_u32 s50, 0
    s_cselect_b32 s63, 1073741824, s63
    s_add_u32 s60, s60, s50
    s_add_u32 s60, s60, 1
    s_lshl_b32 s92, s60, 11
    s_add_u32 s92, s92, s61
    s_cmp_ge_u32 s60, 43
    s_cselect_b32 s92, 1073741824, s92
    s_lshl_b32 s65, s44, 14
    s_lshl_b32 s60, s52, 7
    s_add_u32 s65, s65, s60
    s_waitcnt lgkmcnt(0)
    s_mov_b32 s12, s10
    s_mov_b32 s13, s11
    s_mov_b32 s14, 1572864
    s_mov_b32 s15, 0x00020000
    s_mov_b32 s10, 2097152
    s_mov_b32 s11, 0x00020000
    s_mov_b32 s32, s38
    s_mov_b32 s33, s39
    s_mov_b32 s34, 2097152
    s_mov_b32 s35, 0x00020000
    s_mov_b32 s38, 1024
    s_mov_b32 s39, 0x00020000
    s_mov_b32 s95, 0
    s_mov_b32 s7, 0
    s_cmp_lg_u32 s46, 15
    s_cbranch_scc1 Lgs_1
    s_cmp_lt_u32 s44, 2
    s_cbranch_scc1 Lgs_1
    s_mov_b32 s95, 0x30000
    s_cmp_lg_u32 s44, 2
    s_cbranch_scc1 Lgs_1
    s_mov_b32 s7, 1
    v_lshlrev_b32 v15, 1, v1
    buffer_load_ushort v48, v15, s[36:39], 0 offen offset:0
    buffer_load_ushort v49, v15, s[36:39], 0 offen offset:128
    buffer_load_ushort v50, v15, s[36:39], 0 offen offset:256
    buffer_load_ushort v51, v15, s[36:39], 0 offen offset:384
    buffer_load_ushort v52, v15, s[36:39], 0 offen offset:512
    buffer_load_ushort v53, v15, s[36:39], 0 offen offset:640
    buffer_load_ushort v54, v15, s[36:39], 0 offen offset:768
    buffer_load_ushort v55, v15, s[36:39], 0 offen offset:896
    s_movk_i32 s60, 192
    v_mul_u32_u24 v24, s60, v1
Lgs_1:
    s_mov_b32 s20, s18
    s_mov_b32 s21, s19
    s_mov_b32 s22, 1409024
    s_mov_b32 s23, 0x00020000
    s_mov_b32 s18, 1409024
    s_mov_b32 s19, 0x00020000
    s_lshr_b32 s54, s2, 3
    s_lshl_b32 s54, s54, 3
    s_add_u32 s54, s54, s44
    s_and_b32 s55, s2, 1
    s_bfe_u32 s60, s2, 0x20001
    s_lshl_b32 s61, s55, 2
    s_add_u32 s61, s61, s60
    s_lshl_b32 s61, s61, 8
    s_add_u32 s61, s61, s54
    s_lshl_b32 s61, s61, 10
    buffer_load_dwordx4 v[224:227], v2, s[8:11], s61 offen
    v_lshrrev_b32 v15, 4, v1
    s_movk_i32 s61, 3072
    v_mul_u32_u24 v15, s61, v15
    v_and_b32 v16, 15, v1
    v_lshl_add_u32 v15, v16, 4, v15
    s_and_b32 s61, s54, 63
    s_lshl_b32 s67, s55, 6
    s_add_u32 s61, s61, s67
    s_mul_i32 s61, s61, 12288
    s_lshr_b32 s67, s54, 6
    s_sub_u32 s67, 2, s67
    s_lshl_b32 s67, s67, 10
    s_add_u32 s61, s61, s67
    s_lshl_b32 s67, s60, 8
    s_add_u32 s61, s61, s67
    s_cmp_ge_u32 s54, 192
    s_cselect_b32 s61, 1073741824, s61
    buffer_load_dwordx4 v[228:231], v15, s[12:15], s61 offen
    s_lshl_b32 s61, s55, 8
    s_add_u32 s61, s61, s54
    s_mul_i32 s61, s61, 2752
    s_mul_i32 s67, s60, 768
    s_add_u32 s61, s61, s67
    s_and_b32 s61, s61, 0xffffff80
    s_mov_b32 exec_hi, 0xffffff
    buffer_load_dwordx4 v[232:235], v2, s[16:19], s61 offen
    s_mov_b32 exec_hi, -1
    s_add_u32 s54, s53, 0
    s_add_u32 m0, s66, 0
    s_nop 0
    buffer_load_dwordx4 v3, s[8:11], s54 offen lds
    s_add_u32 s54, s53, 4096
    s_add_u32 m0, s66, 1024
    s_nop 0
    buffer_load_dwordx4 v4, s[8:11], s54 offen lds
    s_add_u32 s54, s53, 8192
    s_add_u32 m0, s66, 2048
    s_nop 0
    buffer_load_dwordx4 v5, s[8:11], s54 offen lds
    s_add_u32 s54, s53, 12288
    s_add_u32 m0, s66, 3072
    s_nop 0
    buffer_load_dwordx4 v6, s[8:11], s54 offen lds
    s_add_u32 s54, s57, 0
    s_add_u32 m0, s76, 32768
    s_nop 0
    buffer_load_dwordx4 v7, s[12:15], s54 offen lds
    s_add_u32 s54, s57, 24576
    s_add_u32 m0, s76, 33792
    s_nop 0
    buffer_load_dwordx4 v7, s[12:15], s54 offen lds
    s_mov_b32 s26, 524288
    s_mov_b32 s27, 0x00020000
    s_mov_b32 s28, s42
    s_mov_b32 s29, s43
    s_mov_b32 s30, 16777216
    s_mov_b32 s31, 0x00020000
    s_mov_b32 s42, 256
    s_mov_b32 s43, 0x00020000
    s_lshl_b32 s54, s44, 21
    s_buffer_load_dword s67, s[28:31], s54
    s_add_u32 s54, s54, 0x100000
    s_buffer_load_dword s67, s[28:31], s54
    s_lshl_b32 s54, s44, 18
    s_buffer_load_dword s67, s[32:35], s54
    s_buffer_load_dword s67, s[20:23], s54
    s_buffer_load_dword s67, s[24:27], s54
    s_buffer_load_dword s67, s[40:43], 128
    s_or_b32 s58, s58, 1
    s_or_b32 s54, s44, s2
    s_cmp_lg_u32 s54, 0
    s_cbranch_scc1 Lcas_2
    v_mov_b32 v20, s58
    v_mov_b32 v21, s59
    v_mov_b32 v28, 0
    s_mov_b64 s[68:69], exec
    s_mov_b64 exec, 1
    buffer_store_dwordx2 v[20:21], v28, s[40:43], 0 offen sc1
    s_mov_b64 exec, s[68:69]
Lcas_2:
    s_lshl_b32 s54, s45, 2
    s_add_u32 s54, s54, s49
    s_lshl_b32 s94, s54, 15
    s_lshl_b32 s55, s46, 1
    s_add_u32 s55, s55, s50
    s_lshl_b32 s55, s55, 10
    s_add_u32 s94, s94, s55
    s_add_u32 s94, s94, 6291456
    v_mov_b32 v96, -1
    v_mov_b32 v97, -1
    v_mov_b32 v98, -1
    v_mov_b32 v99, -1
    buffer_store_dwordx4 v[96:99], v2, s[28:31], s94 offen sc1
    v_and_b32 v15, 31, v1
    v_lshrrev_b32 v17, 5, v1
    v_and_b32 v16, 15, v1
    v_xor_b32 v16, v16, v17
    v_lshlrev_b32 v16, 4, v16
    v_lshl_add_u32 v10, v15, 8, v16
    s_lshl_b32 s54, s49, 13
    v_add_u32 v10, s54, v10
    v_and_b32 v15, 15, v1
    v_lshrrev_b32 v16, 2, v15
    v_bfe_u32 v18, v1, 4, 1
    v_bfe_u32 v19, v1, 1, 1
    v_lshl_add_u32 v18, v18, 1, v19
    v_and_b32 v19, 1, v1
    v_lshlrev_b32 v19, 3, v19
    v_lshl_add_u32 v18, v18, 4, v19
    v_lshrrev_b32 v19, 1, v16
    v_xor_b32 v28, s50, v19
    v_lshl_add_u32 v28, v28, 6, v18
    v_lshl_add_u32 v29, v17, 3, v16
    v_lshl_add_u32 v11, v29, 7, v28
    s_cmp_eq_u32 s50, 0
    s_movk_i32 s54, 192
    s_cselect_b32 s54, 64, s54
    s_lshl_b32 s93, s54, 4
    s_lshl_b32 s55, s50, 12
    v_mad_u32_u24 v12, v29, s54, v18
    v_add_u32 v12, s55, v12
    s_lshl_b32 s54, s54, 2
    v_add_u32 v26, s54, v12
    s_movk_i32 s54, 192
    v_mad_u32_u24 v30, v29, s54, v18
    s_lshl_b32 s55, s50, 6
    s_add_u32 s55, s55, 4160
    v_add_u32 v30, s55, v30
    v_lshl_add_u32 v28, v19, 6, v18
    v_lshl_add_u32 v29, v17, 2, v16
    v_lshl_add_u32 v13, v29, 7, v28
    s_lshl_b32 s54, s49, 11
    v_add_u32 v13, s54, v13
    v_xor_b32 v31, 64, v13
    s_cmp_lt_u32 s44, 2
    s_cbranch_scc1 Lwq_3
    s_mov_b32 s88, s16
    s_mov_b32 s89, s17
    s_mov_b32 s90, 1409024
    s_mov_b32 s91, 0x00020000
    s_sub_u32 s54, s44, 2
    s_lshl_b32 s54, s54, 7
    s_movk_i32 s60, 2752
    s_movk_i32 s61, 5462
    v_add_u32 v15, s54, v1
    v_mul_u32_u24 v16, s61, v15
    v_lshrrev_b32 v16, 16, v16
    v_mul_u32_u24 v18, 12, v16
    v_sub_u32 v15, v15, v18
    v_lshlrev_b32 v15, 4, v15
    v_mad_u32_u24 v8, v16, s60, v15
    v_add_u32 v15, s54, v1
    v_add_u32 v15, 64, v15
    v_mul_u32_u24 v16, s61, v15
    v_lshrrev_b32 v16, 16, v16
    v_mul_u32_u24 v18, 12, v16
    v_sub_u32 v15, v15, v18
    v_lshlrev_b32 v15, 4, v15
    v_mad_u32_u24 v9, v16, s60, v15
    s_mul_i32 s5, s46, 192
    s_cmp_eq_u32 s46, 15
    s_cselect_b32 s5, 1073741824, s5
    s_mov_b32 s87, 176128
    s_branch Lwj_4
Lwq_3:
    s_mov_b32 s88, s12
    s_mov_b32 s89, s13
    s_mov_b32 s90, 1572864
    s_mov_b32 s91, 0x00020000
    s_lshl_b32 s54, s44, 5
    s_movk_i32 s60, 3072
    v_lshrrev_b32 v16, 2, v1
    v_add_u32 v16, s54, v16
    v_and_b32 v15, 3, v1
    v_lshlrev_b32 v15, 4, v15
    v_mad_u32_u24 v8, v16, s60, v15
    v_add_u32 v9, 49152, v8
    s_lshl_b32 s5, s46, 6
    s_mov_b32 s87, 196608
Lwj_4:
    s_lshl_b32 s54, s45, 4
    s_add_u32 s6, s54, s46
    s_lshl_b32 s6, s6, 7
    s_add_u32 s6, s6, 15728640
    s_lshl_b32 s55, s47, 1
    s_add_u32 s54, s54, s55
    v_lshrrev_b32 v25, 1, v1
    v_lshlrev_b32 v25, 4, v25
    v_sub_u32 v25, s54, v25
    v_and_b32 v15, 1, v1
    v_add_u32 v25, v25, v15
    v_and_b32 v25, 255, v25
    v_lshlrev_b32 v25, 7, v25
    v_add_u32 v25, 15728640, v25
    s_mov_b32 s70, 63
    s_cmp_eq_u32 s45, 1
    s_cselect_b32 s70, 15, s70
    s_cmp_eq_u32 s45, 0
    s_cselect_b32 s70, 3, s70
    s_mov_b32 s71, 0
    s_lshl_b32 s60, s46, 6
    s_lshl_b32 s61, s45, 2
    s_add_u32 s60, s60, s61
    s_lshl_b32 s60, s60, 11
    s_mul_i32 s61, s44, 3072
    s_add_u32 s3, s60, s61
    s_lshl_b32 s54, s49, 11
    s_lshl_b32 s55, s50, 10
    s_add_u32 s55, s55, s54
    s_add_u32 s4, s55, 98304
    s_lshl_b32 s55, s50, 8
    s_add_u32 s55, s55, s54
    s_add_u32 s98, s55, 65536
    s_lshl_b32 s79, s45, 2
    s_add_u32 s79, s79, s49
    s_sub_i32 s64, 8, s79
    s_max_i32 s64, s64, 0
    s_mov_b32 s80, 0xffff
    s_mov_b32 s81, 0xffff
    s_lshl_b32 s60, s51, 1
    s_add_u32 s60, s60, s50
    s_mul_i32 s77, s60, 88064
    s_lshl_b32 s54, s49, 10
    s_add_u32 s77, s77, s54
    s_add_u32 s77, s77, 8388608
    s_lshl_b32 s78, s60, 15
    s_add_u32 s78, s78, s54
    s_add_u32 s78, s78, 6291456
    s_lshl_b32 s86, s60, 7
    s_add_u32 s86, s86, 14680064
    s_lshl_b32 s54, s46, 3
    s_add_u32 s54, s54, s44
    s_lshl_b32 s54, s54, 3
    s_lshl_b32 s99, s45, 10
    s_add_u32 s99, s99, s54
    s_add_u32 s99, s99, 15761408
    s_lshr_b32 s100, s51, 1
    s_lshl_b32 s100, s100, 10
    s_add_u32 s100, s100, 15761408
    s_cmp_lg_u32 s7, 0
    s_cbranch_scc1 Lmk_5
    v_and_b32 v18, 31, v1
    v_lshlrev_b32 v19, 2, v17
    v_sub_u32 v18, v18, v19
    v_mov_b32 v19, 0xf149f2ca
    v_cmp_gt_i32 vcc, 0, v18
    s_nop 1
    v_cndmask_b32 v48, 0, v19, vcc
    v_cmp_gt_i32 vcc, 1, v18
    s_nop 1
    v_cndmask_b32 v49, 0, v19, vcc
    v_cmp_gt_i32 vcc, 2, v18
    s_nop 1
    v_cndmask_b32 v50, 0, v19, vcc
    v_cmp_gt_i32 vcc, 3, v18
    s_nop 1
    v_cndmask_b32 v51, 0, v19, vcc
    v_cmp_gt_i32 vcc, 8, v18
    s_nop 1
    v_cndmask_b32 v52, 0, v19, vcc
    v_cmp_gt_i32 vcc, 9, v18
    s_nop 1
    v_cndmask_b32 v53, 0, v19, vcc
    v_cmp_gt_i32 vcc, 10, v18
    s_nop 1
    v_cndmask_b32 v54, 0, v19, vcc
    v_cmp_gt_i32 vcc, 11, v18
    s_nop 1
    v_cndmask_b32 v55, 0, v19, vcc
    v_cmp_gt_i32 vcc, 16, v18
    s_nop 1
    v_cndmask_b32 v56, 0, v19, vcc
    v_cmp_gt_i32 vcc, 17, v18
    s_nop 1
    v_cndmask_b32 v57, 0, v19, vcc
    v_cmp_gt_i32 vcc, 18, v18
    s_nop 1
    v_cndmask_b32 v58, 0, v19, vcc
    v_cmp_gt_i32 vcc, 19, v18
    s_nop 1
    v_cndmask_b32 v59, 0, v19, vcc
    v_cmp_gt_i32 vcc, 24, v18
    s_nop 1
    v_cndmask_b32 v60, 0, v19, vcc
    v_cmp_gt_i32 vcc, 25, v18
    s_nop 1
    v_cndmask_b32 v61, 0, v19, vcc
    v_cmp_gt_i32 vcc, 26, v18
    s_nop 1
    v_cndmask_b32 v62, 0, v19, vcc
    v_cmp_gt_i32 vcc, 27, v18
    s_nop 1
    v_cndmask_b32 v63, 0, v19, vcc
Lmk_5:
    s_barrier
    s_add_u32 s54, s53, 256
    s_add_u32 m0, s66, 65536
    s_nop 0
    buffer_load_dwordx4 v3, s[8:11], s54 offen lds
    s_add_u32 s54, s53, 4352
    s_add_u32 m0, s66, 66560
    s_nop 0
    buffer_load_dwordx4 v4, s[8:11], s54 offen lds
    s_add_u32 s54, s53, 8448
    s_add_u32 m0, s66, 67584
    s_nop 0
    buffer_load_dwordx4 v5, s[8:11], s54 offen lds
    s_add_u32 s54, s53, 12544
    s_add_u32 m0, s66, 68608
    s_nop 0
    buffer_load_dwordx4 v6, s[8:11], s54 offen lds
    s_add_u32 s54, s57, 393216
    s_add_u32 m0, s76, 49152
    s_nop 0
    buffer_load_dwordx4 v7, s[12:15], s54 offen lds
    s_add_u32 s54, s57, 417792
    s_add_u32 m0, s76, 50176
    s_nop 0
    buffer_load_dwordx4 v7, s[12:15], s54 offen lds
    s_cmp_lg_u32 s48, 0
    s_cbranch_scc1 L_s1v
    s_waitcnt vmcnt(7) lgkmcnt(0)
    s_barrier
    v_xor_b32 v15, 0, v10
    ds_read_b128 v[128:131], v15 offset:0
    ds_read_b64_tr_b16 v[64:65], v11 offset:32768
    ds_read_b64_tr_b16 v[66:67], v11 offset:33280
    v_xor_b32 v16, 32, v10
    ds_read_b128 v[132:135], v16 offset:0
    ds_read_b64_tr_b16 v[68:69], v11 offset:34816
    ds_read_b64_tr_b16 v[70:71], v11 offset:35328
    v_xor_b32 v15, 64, v10
    ds_read_b128 v[136:139], v15 offset:0
    ds_read_b64_tr_b16 v[72:73], v11 offset:36864
    ds_read_b64_tr_b16 v[74:75], v11 offset:37376
    v_xor_b32 v16, 96, v10
    ds_read_b128 v[140:143], v16 offset:0
    ds_read_b64_tr_b16 v[76:77], v11 offset:38912
    ds_read_b64_tr_b16 v[78:79], v11 offset:39424
    v_xor_b32 v15, 128, v10
    ds_read_b128 v[144:147], v15 offset:0
    ds_read_b64_tr_b16 v[80:81], v11 offset:40960
    ds_read_b64_tr_b16 v[82:83], v11 offset:41472
    v_xor_b32 v16, 160, v10
    ds_read_b128 v[148:151], v16 offset:0
    ds_read_b64_tr_b16 v[84:85], v11 offset:43008
    ds_read_b64_tr_b16 v[86:87], v11 offset:43520
    s_waitcnt lgkmcnt(15)
    v_mfma_f32_32x32x16_bf16 v[32:47], v[64:67], v[128:131], 0
    s_add_u32 s54, s53, 512
    s_add_u32 m0, s66, 98304
    s_nop 0
    buffer_load_dwordx4 v3, s[8:11], s54 offen lds
    v_xor_b32 v15, 192, v10
    ds_read_b128 v[152:155], v15 offset:0
    ds_read_b64_tr_b16 v[88:89], v11 offset:45056
    ds_read_b64_tr_b16 v[90:91], v11 offset:45568
    s_waitcnt lgkmcnt(15)
    v_mfma_f32_32x32x16_bf16 v[32:47], v[68:71], v[132:135], v[32:47]
    s_add_u32 s54, s53, 4608
    s_add_u32 m0, s66, 99328
    s_nop 0
    buffer_load_dwordx4 v4, s[8:11], s54 offen lds
    v_xor_b32 v16, 224, v10
    ds_read_b128 v[156:159], v16 offset:0
    ds_read_b64_tr_b16 v[92:93], v11 offset:47104
    ds_read_b64_tr_b16 v[94:95], v11 offset:47616
    s_waitcnt lgkmcnt(15)
    v_mfma_f32_32x32x16_bf16 v[32:47], v[72:75], v[136:139], v[32:47]
    s_add_u32 s54, s53, 8704
    s_add_u32 m0, s66, 100352
    s_nop 0
    buffer_load_dwordx4 v5, s[8:11], s54 offen lds
    s_waitcnt lgkmcnt(12)
    v_mfma_f32_32x32x16_bf16 v[32:47], v[76:79], v[140:143], v[32:47]
    s_add_u32 s54, s53, 12800
    s_add_u32 m0, s66, 101376
    s_nop 0
    buffer_load_dwordx4 v6, s[8:11], s54 offen lds
    s_waitcnt lgkmcnt(9)
    v_mfma_f32_32x32x16_bf16 v[32:47], v[80:83], v[144:147], v[32:47]
    s_add_u32 s54, s57, 786432
    s_add_u32 m0, s76, 131072
    s_nop 0
    buffer_load_dwordx4 v7, s[12:15], s54 offen lds
    s_add_u32 s54, s57, 811008
    s_add_u32 m0, s76, 132096
    s_nop 0
    buffer_load_dwordx4 v7, s[12:15], s54 offen lds
    s_add_u32 s54, s57, 1179648
    s_add_u32 m0, s76, 147456
    s_nop 0
    buffer_load_dwordx4 v7, s[12:15], s54 offen lds
    s_add_u32 s54, s57, 1204224
    s_add_u32 m0, s76, 148480
    s_nop 0
    buffer_load_dwordx4 v7, s[12:15], s54 offen lds
    s_waitcnt vmcnt(8) lgkmcnt(0)
    s_barrier
    s_lshl_b32 s54, s2, 3
    s_add_u32 s54, s54, s44
    s_lshl_b32 s54, s54, 10
    buffer_load_dwordx4 v[240:243], v2, s[20:23], s54 offen
    buffer_load_dwordx4 v[244:247], v2, s[24:27], s54 offen
    v_xor_b32 v15, 0, v10
    v_add_u32 v15, 65536, v15
    ds_read_b128 v[160:163], v15 offset:0
    ds_read_b64_tr_b16 v[64:65], v11 offset:49152
    ds_read_b64_tr_b16 v[66:67], v11 offset:49664
    v_xor_b32 v16, 32, v10
    v_add_u32 v16, 65536, v16
    ds_read_b128 v[164:167], v16 offset:0
    ds_read_b64_tr_b16 v[68:69], v11 offset:51200
    ds_read_b64_tr_b16 v[70:71], v11 offset:51712
    v_mfma_f32_32x32x16_bf16 v[32:47], v[84:87], v[148:151], v[32:47]
    s_add_u32 s54, s53, 768
    s_add_u32 m0, s66, 0
    s_nop 0
    buffer_load_dwordx4 v3, s[8:11], s54 offen lds
    v_xor_b32 v15, 64, v10
    v_add_u32 v15, 65536, v15
    ds_read_b128 v[168:171], v15 offset:0
    ds_read_b64_tr_b16 v[72:73], v11 offset:53248
    ds_read_b64_tr_b16 v[74:75], v11 offset:53760
    v_xor_b32 v16, 96, v10
    v_add_u32 v16, 65536, v16
    ds_read_b128 v[172:175], v16 offset:0
    ds_read_b64_tr_b16 v[76:77], v11 offset:55296
    ds_read_b64_tr_b16 v[78:79], v11 offset:55808
    v_mfma_f32_32x32x16_bf16 v[32:47], v[88:91], v[152:155], v[32:47]
    s_add_u32 s54, s53, 4864
    s_add_u32 m0, s66, 1024
    s_nop 0
    buffer_load_dwordx4 v4, s[8:11], s54 offen lds
    v_xor_b32 v15, 128, v10
    v_add_u32 v15, 65536, v15
    ds_read_b128 v[176:179], v15 offset:0
    ds_read_b64_tr_b16 v[80:81], v11 offset:57344
    ds_read_b64_tr_b16 v[82:83], v11 offset:57856
    v_mfma_f32_32x32x16_bf16 v[32:47], v[92:95], v[156:159], v[32:47]
    s_add_u32 s54, s53, 8960
    s_add_u32 m0, s66, 2048
    s_nop 0
    buffer_load_dwordx4 v5, s[8:11], s54 offen lds
    v_xor_b32 v16, 160, v10
    v_add_u32 v16, 65536, v16
    ds_read_b128 v[180:183], v16 offset:0
    ds_read_b64_tr_b16 v[84:85], v11 offset:59392
    ds_read_b64_tr_b16 v[86:87], v11 offset:59904
    s_waitcnt lgkmcnt(15)
    v_mfma_f32_32x32x16_bf16 v[32:47], v[64:67], v[160:163], v[32:47]
    s_add_u32 s54, s53, 13056
    s_add_u32 m0, s66, 3072
    s_nop 0
    buffer_load_dwordx4 v6, s[8:11], s54 offen lds
    v_xor_b32 v15, 192, v10
    v_add_u32 v15, 65536, v15
    ds_read_b128 v[184:187], v15 offset:0
    ds_read_b64_tr_b16 v[88:89], v11 offset:61440
    ds_read_b64_tr_b16 v[90:91], v11 offset:61952
    s_waitcnt lgkmcnt(15)
    v_mfma_f32_32x32x16_bf16 v[32:47], v[68:71], v[164:167], v[32:47]
    s_mul_i32 s56, s87, 0
    s_add_u32 s56, s56, s5
    s_add_u32 s54, s76, 32768
    s_max_u32 m0, s54, s95
    s_nop 0
    buffer_load_dwordx4 v8, s[88:91], s56 offen lds
    v_xor_b32 v16, 224, v10
    v_add_u32 v16, 65536, v16
    ds_read_b128 v[188:191], v16 offset:0
    ds_read_b64_tr_b16 v[92:93], v11 offset:63488
    ds_read_b64_tr_b16 v[94:95], v11 offset:64000
    s_waitcnt lgkmcnt(15)
    v_mfma_f32_32x32x16_bf16 v[32:47], v[72:75], v[168:171], v[32:47]
    s_add_u32 s54, s76, 33792
    s_max_u32 m0, s54, s95
    s_nop 0
    buffer_load_dwordx4 v9, s[88:91], s56 offen lds
    s_cmp_eq_u32 s7, 0
    s_cbranch_scc1 Lgw_6
    v_add_u32 v18, 36992, v24
    ds_write_b16 v18, v48
Lgw_6:
    s_waitcnt lgkmcnt(12)
    v_mfma_f32_32x32x16_bf16 v[32:47], v[76:79], v[172:175], v[32:47]
    s_waitcnt lgkmcnt(9)
    v_mfma_f32_32x32x16_bf16 v[32:47], v[80:83], v[176:179], v[32:47]
    s_waitcnt vmcnt(10) lgkmcnt(0)
    s_barrier
    v_mov_b32 v18, 0
    buffer_load_dwordx2 v[20:21], v18, s[40:43], 0 offen sc1
    v_xor_b32 v15, 0, v10
    v_add_u32 v15, 98304, v15
    ds_read_b128 v[192:195], v15 offset:0
    v_add_u32 v28, 131072, v11
    ds_read_b64_tr_b16 v[64:65], v28 offset:0
    ds_read_b64_tr_b16 v[66:67], v28 offset:512
    v_xor_b32 v16, 32, v10
    v_add_u32 v16, 98304, v16
    ds_read_b128 v[196:199], v16 offset:0
    ds_read_b64_tr_b16 v[68:69], v28 offset:2048
    ds_read_b64_tr_b16 v[70:71], v28 offset:2560
    v_mfma_f32_32x32x16_bf16 v[32:47], v[84:87], v[180:183], v[32:47]
    s_mul_i32 s56, s87, 1
    s_add_u32 s56, s56, s5
    s_add_u32 s54, s76, 65536
    s_max_u32 m0, s54, s95
    s_nop 0
    buffer_load_dwordx4 v8, s[88:91], s56 offen lds
    v_xor_b32 v15, 64, v10
    v_add_u32 v15, 98304, v15
    ds_read_b128 v[200:203], v15 offset:0
    ds_read_b64_tr_b16 v[72:73], v28 offset:4096
    ds_read_b64_tr_b16 v[74:75], v28 offset:4608
    v_xor_b32 v16, 96, v10
    v_add_u32 v16, 98304, v16
    ds_read_b128 v[204:207], v16 offset:0
    ds_read_b64_tr_b16 v[76:77], v28 offset:6144
    ds_read_b64_tr_b16 v[78:79], v28 offset:6656
    v_mfma_f32_32x32x16_bf16 v[32:47], v[88:91], v[184:187], v[32:47]
    s_add_u32 s54, s76, 66560
    s_max_u32 m0, s54, s95
    s_nop 0
    buffer_load_dwordx4 v9, s[88:91], s56 offen lds
    s_cmp_eq_u32 s7, 0
    s_cbranch_scc1 Lgw_7
    v_add_u32 v18, 69760, v24
    ds_write_b16 v18, v49
Lgw_7:
    v_xor_b32 v15, 128, v10
    v_add_u32 v15, 98304, v15
    ds_read_b128 v[208:211], v15 offset:0
    ds_read_b64_tr_b16 v[80:81], v28 offset:8192
    ds_read_b64_tr_b16 v[82:83], v28 offset:8704
    v_mfma_f32_32x32x16_bf16 v[32:47], v[92:95], v[188:191], v[32:47]
    s_mul_i32 s56, s87, 2
    s_add_u32 s56, s56, s5
    s_add_u32 s54, s76, 81920
    s_max_u32 m0, s54, s95
    s_nop 0
    buffer_load_dwordx4 v8, s[88:91], s56 offen lds
    v_xor_b32 v16, 160, v10
    v_add_u32 v16, 98304, v16
    ds_read_b128 v[212:215], v16 offset:0
    ds_read_b64_tr_b16 v[84:85], v28 offset:10240
    ds_read_b64_tr_b16 v[86:87], v28 offset:10752
    s_waitcnt lgkmcnt(15)
    v_mfma_f32_32x32x16_bf16 v[32:47], v[64:67], v[192:195], v[32:47]
    s_add_u32 s54, s76, 82944
    s_max_u32 m0, s54, s95
    s_nop 0
    buffer_load_dwordx4 v9, s[88:91], s56 offen lds
    s_cmp_eq_u32 s7, 0
    s_cbranch_scc1 Lgw_8
    v_add_u32 v18, 86144, v24
    ds_write_b16 v18, v50
Lgw_8:
    v_xor_b32 v15, 192, v10
    v_add_u32 v15, 98304, v15
    ds_read_b128 v[216:219], v15 offset:0
    ds_read_b64_tr_b16 v[88:89], v28 offset:12288
    ds_read_b64_tr_b16 v[90:91], v28 offset:12800
    s_waitcnt lgkmcnt(15)
    v_mfma_f32_32x32x16_bf16 v[32:47], v[68:71], v[196:199], v[32:47]
    s_mul_i32 s56, s87, 3
    s_add_u32 s56, s56, s5
    s_add_u32 s54, s76, 49152
    s_max_u32 m0, s54, s95
    s_nop 0
    buffer_load_dwordx4 v8, s[88:91], s56 offen lds
    v_xor_b32 v16, 224, v10
    v_add_u32 v16, 98304, v16
    ds_read_b128 v[220:223], v16 offset:0
    ds_read_b64_tr_b16 v[92:93], v28 offset:14336
    ds_read_b64_tr_b16 v[94:95], v28 offset:14848
    s_waitcnt lgkmcnt(15)
    v_mfma_f32_32x32x16_bf16 v[32:47], v[72:75], v[200:203], v[32:47]
    s_add_u32 s54, s76, 50176
    s_max_u32 m0, s54, s95
    s_nop 0
    buffer_load_dwordx4 v9, s[88:91], s56 offen lds
    s_cmp_eq_u32 s7, 0
    s_cbranch_scc1 Lgw_9
    v_add_u32 v18, 53376, v24
    ds_write_b16 v18, v51
Lgw_9:
    s_waitcnt lgkmcnt(12)
    v_mfma_f32_32x32x16_bf16 v[32:47], v[76:79], v[204:207], v[32:47]
    s_waitcnt lgkmcnt(9)
    v_mfma_f32_32x32x16_bf16 v[32:47], v[80:83], v[208:211], v[32:47]
    s_waitcnt vmcnt(9) lgkmcnt(0)
    s_barrier
    s_cmp_lg_u32 s44, 7
    s_cbranch_scc1 Ltlb_10
    v_lshlrev_b32 v18, 20, v1
    s_mov_b64 exec, 0xffff
    buffer_load_dword v3, v18, s[28:31], 0 offen
    s_mov_b64 exec, 0xff
    v_lshlrev_b32 v18, 18, v1
    buffer_load_dword v4, v18, s[32:35], 0 offen
    s_mov_b64 exec, -1
Ltlb_10:
    v_xor_b32 v15, 0, v10
    ds_read_b128 v[224:227], v15 offset:0
    v_add_u32 v28, 147456, v11
    ds_read_b64_tr_b16 v[64:65], v28 offset:0
    ds_read_b64_tr_b16 v[66:67], v28 offset:512
    v_xor_b32 v16, 32, v10
    ds_read_b128 v[228:231], v16 offset:0
    ds_read_b64_tr_b16 v[68:69], v28 offset:2048
    ds_read_b64_tr_b16 v[70:71], v28 offset:2560
    v_mfma_f32_32x32x16_bf16 v[32:47], v[84:87], v[212:215], v[32:47]
    s_mul_i32 s56, s87, 4
    s_add_u32 s56, s56, s5
    s_add_u32 s54, s76, 98304
    s_max_u32 m0, s54, s95
    s_nop 0
    buffer_load_dwordx4 v8, s[88:91], s56 offen lds
    v_xor_b32 v15, 64, v10
    ds_read_b128 v[232:235], v15 offset:0
    ds_read_b64_tr_b16 v[72:73], v28 offset:4096
    ds_read_b64_tr_b16 v[74:75], v28 offset:4608
    v_xor_b32 v16, 96, v10
    ds_read_b128 v[236:239], v16 offset:0
    ds_read_b64_tr_b16 v[76:77], v28 offset:6144
    ds_read_b64_tr_b16 v[78:79], v28 offset:6656
    v_mfma_f32_32x32x16_bf16 v[32:47], v[88:91], v[216:219], v[32:47]
    s_add_u32 s54, s76, 99328
    s_max_u32 m0, s54, s95
    s_nop 0
    buffer_load_dwordx4 v9, s[88:91], s56 offen lds
    s_cmp_eq_u32 s7, 0
    s_cbranch_scc1 Lgw_11
    v_add_u32 v18, 102528, v24
    ds_write_b16 v18, v52
Lgw_11:
    v_xor_b32 v15, 128, v10
    ds_read_b128 v[240:243], v15 offset:0
    ds_read_b64_tr_b16 v[80:81], v28 offset:8192
    ds_read_b64_tr_b16 v[82:83], v28 offset:8704
    v_mfma_f32_32x32x16_bf16 v[32:47], v[92:95], v[220:223], v[32:47]
    s_mul_i32 s56, s87, 5
    s_add_u32 s56, s56, s5
    s_add_u32 s54, s76, 114688
    s_max_u32 m0, s54, s95
    s_nop 0
    buffer_load_dwordx4 v8, s[88:91], s56 offen lds
    v_xor_b32 v16, 160, v10
    ds_read_b128 v[244:247], v16 offset:0
    ds_read_b64_tr_b16 v[84:85], v28 offset:10240
    ds_read_b64_tr_b16 v[86:87], v28 offset:10752
    s_waitcnt lgkmcnt(15)
    v_mfma_f32_32x32x16_bf16 v[32:47], v[64:67], v[224:227], v[32:47]
    s_add_u32 s54, s76, 115712
    s_max_u32 m0, s54, s95
    s_nop 0
    buffer_load_dwordx4 v9, s[88:91], s56 offen lds
    s_cmp_eq_u32 s7, 0
    s_cbranch_scc1 Lgw_12
    v_add_u32 v18, 118912, v24
    ds_write_b16 v18, v53
Lgw_12:
    v_xor_b32 v15, 192, v10
    ds_read_b128 v[248:251], v15 offset:0
    ds_read_b64_tr_b16 v[88:89], v28 offset:12288
    ds_read_b64_tr_b16 v[90:91], v28 offset:12800
    s_waitcnt lgkmcnt(15)
    v_mfma_f32_32x32x16_bf16 v[32:47], v[68:71], v[228:231], v[32:47]
    s_mul_i32 s56, s87, 6
    s_add_u32 s56, s56, s5
    s_add_u32 s54, s76, 131072
    s_max_u32 m0, s54, s95
    s_nop 0
    buffer_load_dwordx4 v8, s[88:91], s56 offen lds
    v_xor_b32 v16, 224, v10
    ds_read_b128 v[252:255], v16 offset:0
    ds_read_b64_tr_b16 v[92:93], v28 offset:14336
    ds_read_b64_tr_b16 v[94:95], v28 offset:14848
    s_waitcnt lgkmcnt(15)
    v_mfma_f32_32x32x16_bf16 v[32:47], v[72:75], v[232:235], v[32:47]
    s_add_u32 s54, s76, 132096
    s_max_u32 m0, s54, s95
    s_nop 0
    buffer_load_dwordx4 v9, s[88:91], s56 offen lds
    s_cmp_eq_u32 s7, 0
    s_cbranch_scc1 Lgw_13
    v_add_u32 v18, 135296, v24
    ds_write_b16 v18, v54
Lgw_13:
    s_waitcnt lgkmcnt(12)
    v_mfma_f32_32x32x16_bf16 v[32:47], v[76:79], v[236:239], v[32:47]
    s_waitcnt lgkmcnt(9)
    v_mfma_f32_32x32x16_bf16 v[32:47], v[80:83], v[240:243], v[32:47]
    s_waitcnt vmcnt(13) lgkmcnt(0)
    s_barrier
    v_add_u32 v28, 32768, v12
    v_add_u32 v15, 32768, v26
    ds_read_b64_tr_b16 v[64:65], v28
    ds_read_b64_tr_b16 v[66:67], v15
    ds_read_b64_tr_b16 v[68:69], v30 offset:32768
    ds_read_b64_tr_b16 v[70:71], v30 offset:33536
    v_mfma_f32_32x32x16_bf16 v[32:47], v[84:87], v[244:247], v[32:47]
    s_mul_i32 s56, s87, 7
    s_add_u32 s56, s56, s5
    s_add_u32 s54, s76, 147456
    s_max_u32 m0, s54, s95
    s_nop 0
    buffer_load_dwordx4 v8, s[88:91], s56 offen lds
    v_add_u32 v28, s93, v28
    v_add_u32 v15, s93, v15
    ds_read_b64_tr_b16 v[72:73], v28
    ds_read_b64_tr_b16 v[74:75], v15
    ds_read_b64_tr_b16 v[76:77], v30 offset:35840
    ds_read_b64_tr_b16 v[78:79], v30 offset:36608
    v_mfma_f32_32x32x16_bf16 v[32:47], v[88:91], v[248:251], v[32:47]
    s_add_u32 s54, s76, 148480
    s_max_u32 m0, s54, s95
    s_nop 0
    buffer_load_dwordx4 v9, s[88:91], s56 offen lds
    s_cmp_eq_u32 s7, 0
    s_cbranch_scc1 Lgw_14
    v_add_u32 v18, 151680, v24
    ds_write_b16 v18, v55
Lgw_14:
    v_add_u32 v28, s93, v28
    v_add_u32 v15, s93, v15
    ds_read_b64_tr_b16 v[80:81], v28
    ds_read_b64_tr_b16 v[82:83], v15
    v_mfma_f32_32x32x16_bf16 v[32:47], v[92:95], v[252:255], v[32:47]
    s_branch L_s1w
L_s1v:
    s_waitcnt vmcnt(7) lgkmcnt(0)
    s_barrier
    v_xor_b32 v15, 0, v10
    ds_read_b128 v[128:131], v15 offset:0
    ds_read_b64_tr_b16 v[64:65], v11 offset:32768
    ds_read_b64_tr_b16 v[66:67], v11 offset:33280
    v_xor_b32 v16, 32, v10
    ds_read_b128 v[132:135], v16 offset:0
    ds_read_b64_tr_b16 v[68:69], v11 offset:34816
    ds_read_b64_tr_b16 v[70:71], v11 offset:35328
    v_xor_b32 v15, 64, v10
    ds_read_b128 v[136:139], v15 offset:0
    ds_read_b64_tr_b16 v[72:73], v11 offset:36864
    ds_read_b64_tr_b16 v[74:75], v11 offset:37376
    v_xor_b32 v16, 96, v10
    ds_read_b128 v[140:143], v16 offset:0
    ds_read_b64_tr_b16 v[76:77], v11 offset:38912
    ds_read_b64_tr_b16 v[78:79], v11 offset:39424
    v_xor_b32 v15, 128, v10
    ds_read_b128 v[144:147], v15 offset:0
    ds_read_b64_tr_b16 v[80:81], v11 offset:40960
    ds_read_b64_tr_b16 v[82:83], v11 offset:41472
    v_xor_b32 v16, 160, v10
    ds_read_b128 v[148:151], v16 offset:0
    ds_read_b64_tr_b16 v[84:85], v11 offset:43008
    ds_read_b64_tr_b16 v[86:87], v11 offset:43520
    s_waitcnt lgkmcnt(15)
    v_mfma_f32_32x32x16_bf16 v[32:47], v[128:131], v[64:67], 0
    s_add_u32 s54, s53, 512
    s_add_u32 m0, s66, 98304
    s_nop 0
    buffer_load_dwordx4 v3, s[8:11], s54 offen lds
    v_xor_b32 v15, 192, v10
    ds_read_b128 v[152:155], v15 offset:0
    ds_read_b64_tr_b16 v[88:89], v11 offset:45056
    ds_read_b64_tr_b16 v[90:91], v11 offset:45568
    s_waitcnt lgkmcnt(15)
    v_mfma_f32_32x32x16_bf16 v[32:47], v[132:135], v[68:71], v[32:47]
    s_add_u32 s54, s53, 4608
    s_add_u32 m0, s66, 99328
    s_nop 0
    buffer_load_dwordx4 v4, s[8:11], s54 offen lds
    v_xor_b32 v16, 224, v10
    ds_read_b128 v[156:159], v16 offset:0
    ds_read_b64_tr_b16 v[92:93], v11 offset:47104
    ds_read_b64_tr_b16 v[94:95], v11 offset:47616
    s_waitcnt lgkmcnt(15)
    v_mfma_f32_32x32x16_bf16 v[32:47], v[136:139], v[72:75], v[32:47]
    s_add_u32 s54, s53, 8704
    s_add_u32 m0, s66, 100352
    s_nop 0
    buffer_load_dwordx4 v5, s[8:11], s54 offen lds
    s_waitcnt lgkmcnt(12)
    v_mfma_f32_32x32x16_bf16 v[32:47], v[140:143], v[76:79], v[32:47]
    s_add_u32 s54, s53, 12800
    s_add_u32 m0, s66, 101376
    s_nop 0
    buffer_load_dwordx4 v6, s[8:11], s54 offen lds
    s_waitcnt lgkmcnt(9)
    v_mfma_f32_32x32x16_bf16 v[32:47], v[144:147], v[80:83], v[32:47]
    s_add_u32 s54, s57, 786432
    s_add_u32 m0, s76, 131072
    s_nop 0
    buffer_load_dwordx4 v7, s[12:15], s54 offen lds
    s_add_u32 s54, s57, 811008
    s_add_u32 m0, s76, 132096
    s_nop 0
    buffer_load_dwordx4 v7, s[12:15], s54 offen lds
    s_add_u32 s54, s57, 1179648
    s_add_u32 m0, s76, 147456
    s_nop 0
    buffer_load_dwordx4 v7, s[12:15], s54 offen lds
    s_add_u32 s54, s57, 1204224
    s_add_u32 m0, s76, 148480
    s_nop 0
    buffer_load_dwordx4 v7, s[12:15], s54 offen lds
    s_waitcnt vmcnt(8) lgkmcnt(0)
    s_barrier
    s_lshl_b32 s54, s2, 3
    s_add_u32 s54, s54, s44
    s_lshl_b32 s54, s54, 10
    buffer_load_dwordx4 v[240:243], v2, s[20:23], s54 offen
    buffer_load_dwordx4 v[244:247], v2, s[24:27], s54 offen
    v_xor_b32 v15, 0, v10
    v_add_u32 v15, 65536, v15
    ds_read_b128 v[160:163], v15 offset:0
    ds_read_b64_tr_b16 v[64:65], v11 offset:49152
    ds_read_b64_tr_b16 v[66:67], v11 offset:49664
    v_xor_b32 v16, 32, v10
    v_add_u32 v16, 65536, v16
    ds_read_b128 v[164:167], v16 offset:0
    ds_read_b64_tr_b16 v[68:69], v11 offset:51200
    ds_read_b64_tr_b16 v[70:71], v11 offset:51712
    v_mfma_f32_32x32x16_bf16 v[32:47], v[148:151], v[84:87], v[32:47]
    s_add_u32 s54, s53, 768
    s_add_u32 m0, s66, 0
    s_nop 0
    buffer_load_dwordx4 v3, s[8:11], s54 offen lds
    v_xor_b32 v15, 64, v10
    v_add_u32 v15, 65536, v15
    ds_read_b128 v[168:171], v15 offset:0
    ds_read_b64_tr_b16 v[72:73], v11 offset:53248
    ds_read_b64_tr_b16 v[74:75], v11 offset:53760
    v_xor_b32 v16, 96, v10
    v_add_u32 v16, 65536, v16
    ds_read_b128 v[172:175], v16 offset:0
    ds_read_b64_tr_b16 v[76:77], v11 offset:55296
    ds_read_b64_tr_b16 v[78:79], v11 offset:55808
    v_mfma_f32_32x32x16_bf16 v[32:47], v[152:155], v[88:91], v[32:47]
    s_add_u32 s54, s53, 4864
    s_add_u32 m0, s66, 1024
    s_nop 0
    buffer_load_dwordx4 v4, s[8:11], s54 offen lds
    v_xor_b32 v15, 128, v10
    v_add_u32 v15, 65536, v15
    ds_read_b128 v[176:179], v15 offset:0
    ds_read_b64_tr_b16 v[80:81], v11 offset:57344
    ds_read_b64_tr_b16 v[82:83], v11 offset:57856
    v_mfma_f32_32x32x16_bf16 v[32:47], v[156:159], v[92:95], v[32:47]
    s_add_u32 s54, s53, 8960
    s_add_u32 m0, s66, 2048
    s_nop 0
    buffer_load_dwordx4 v5, s[8:11], s54 offen lds
    v_xor_b32 v16, 160, v10
    v_add_u32 v16, 65536, v16
    ds_read_b128 v[180:183], v16 offset:0
    ds_read_b64_tr_b16 v[84:85], v11 offset:59392
    ds_read_b64_tr_b16 v[86:87], v11 offset:59904
    s_waitcnt lgkmcnt(15)
    v_mfma_f32_32x32x16_bf16 v[32:47], v[160:163], v[64:67], v[32:47]
    s_add_u32 s54, s53, 13056
    s_add_u32 m0, s66, 3072
    s_nop 0
    buffer_load_dwordx4 v6, s[8:11], s54 offen lds
    v_xor_b32 v15, 192, v10
    v_add_u32 v15, 65536, v15
    ds_read_b128 v[184:187], v15 offset:0
    ds_read_b64_tr_b16 v[88:89], v11 offset:61440
    ds_read_b64_tr_b16 v[90:91], v11 offset:61952
    s_waitcnt lgkmcnt(15)
    v_mfma_f32_32x32x16_bf16 v[32:47], v[164:167], v[68:71], v[32:47]
    s_mul_i32 s56, s87, 0
    s_add_u32 s56, s56, s5
    s_add_u32 s54, s76, 32768
    s_max_u32 m0, s54, s95
    s_nop 0
    buffer_load_dwordx4 v8, s[88:91], s56 offen lds
    v_xor_b32 v16, 224, v10
    v_add_u32 v16, 65536, v16
    ds_read_b128 v[188:191], v16 offset:0
    ds_read_b64_tr_b16 v[92:93], v11 offset:63488
    ds_read_b64_tr_b16 v[94:95], v11 offset:64000
    s_waitcnt lgkmcnt(15)
    v_mfma_f32_32x32x16_bf16 v[32:47], v[168:171], v[72:75], v[32:47]
    s_add_u32 s54, s76, 33792
    s_max_u32 m0, s54, s95
    s_nop 0
    buffer_load_dwordx4 v9, s[88:91], s56 offen lds
    s_cmp_eq_u32 s7, 0
    s_cbranch_scc1 Lgw_15
    v_add_u32 v18, 36992, v24
    ds_write_b16 v18, v48
Lgw_15:
    s_waitcnt lgkmcnt(12)
    v_mfma_f32_32x32x16_bf16 v[32:47], v[172:175], v[76:79], v[32:47]
    s_waitcnt lgkmcnt(9)
    v_mfma_f32_32x32x16_bf16 v[32:47], v[176:179], v[80:83], v[32:47]
    s_waitcnt vmcnt(10) lgkmcnt(0)
    s_barrier
    v_mov_b32 v18, 0
    buffer_load_dwordx2 v[20:21], v18, s[40:43], 0 offen sc1
    v_xor_b32 v15, 0, v10
    v_add_u32 v15, 98304, v15
    ds_read_b128 v[192:195], v15 offset:0
    v_add_u32 v28, 131072, v11
    ds_read_b64_tr_b16 v[64:65], v28 offset:0
    ds_read_b64_tr_b16 v[66:67], v28 offset:512
    v_xor_b32 v16, 32, v10
    v_add_u32 v16, 98304, v16
    ds_read_b128 v[196:199], v16 offset:0
    ds_read_b64_tr_b16 v[68:69], v28 offset:2048
    ds_read_b64_tr_b16 v[70:71], v28 offset:2560
    v_mfma_f32_32x32x16_bf16 v[32:47], v[180:183], v[84:87], v[32:47]
    s_mul_i32 s56, s87, 1
    s_add_u32 s56, s56, s5
    s_add_u32 s54, s76, 65536
    s_max_u32 m0, s54, s95
    s_nop 0
    buffer_load_dwordx4 v8, s[88:91], s56 offen lds
    v_xor_b32 v15, 64, v10
    v_add_u32 v15, 98304, v15
    ds_read_b128 v[200:203], v15 offset:0
    ds_read_b64_tr_b16 v[72:73], v28 offset:4096
    ds_read_b64_tr_b16 v[74:75], v28 offset:4608
    v_xor_b32 v16, 96, v10
    v_add_u32 v16, 98304, v16
    ds_read_b128 v[204:207], v16 offset:0
    ds_read_b64_tr_b16 v[76:77], v28 offset:6144
    ds_read_b64_tr_b16 v[78:79], v28 offset:6656
    v_mfma_f32_32x32x16_bf16 v[32:47], v[184:187], v[88:91], v[32:47]
    s_add_u32 s54, s76, 66560
    s_max_u32 m0, s54, s95
    s_nop 0
    buffer_load_dwordx4 v9, s[88:91], s56 offen lds
    s_cmp_eq_u32 s7, 0
    s_cbranch_scc1 Lgw_16
    v_add_u32 v18, 69760, v24
    ds_write_b16 v18, v49
Lgw_16:
    v_xor_b32 v15, 128, v10
    v_add_u32 v15, 98304, v15
    ds_read_b128 v[208:211], v15 offset:0
    ds_read_b64_tr_b16 v[80:81], v28 offset:8192
    ds_read_b64_tr_b16 v[82:83], v28 offset:8704
    v_mfma_f32_32x32x16_bf16 v[32:47], v[188:191], v[92:95], v[32:47]
    s_mul_i32 s56, s87, 2
    s_add_u32 s56, s56, s5
    s_add_u32 s54, s76, 81920
    s_max_u32 m0, s54, s95
    s_nop 0
    buffer_load_dwordx4 v8, s[88:91], s56 offen lds
    v_xor_b32 v16, 160, v10
    v_add_u32 v16, 98304, v16
    ds_read_b128 v[212:215], v16 offset:0
    ds_read_b64_tr_b16 v[84:85], v28 offset:10240
    ds_read_b64_tr_b16 v[86:87], v28 offset:10752
    s_waitcnt lgkmcnt(15)
    v_mfma_f32_32x32x16_bf16 v[32:47], v[192:195], v[64:67], v[32:47]
    s_add_u32 s54, s76, 82944
    s_max_u32 m0, s54, s95
    s_nop 0
    buffer_load_dwordx4 v9, s[88:91], s56 offen lds
    s_cmp_eq_u32 s7, 0
    s_cbranch_scc1 Lgw_17
    v_add_u32 v18, 86144, v24
    ds_write_b16 v18, v50
Lgw_17:
    v_xor_b32 v15, 192, v10
    v_add_u32 v15, 98304, v15
    ds_read_b128 v[216:219], v15 offset:0
    ds_read_b64_tr_b16 v[88:89], v28 offset:12288
    ds_read_b64_tr_b16 v[90:91], v28 offset:12800
    s_waitcnt lgkmcnt(15)
    v_mfma_f32_32x32x16_bf16 v[32:47], v[196:199], v[68:71], v[32:47]
    s_mul_i32 s56, s87, 3
    s_add_u32 s56, s56, s5
    s_add_u32 s54, s76, 49152
    s_max_u32 m0, s54, s95
    s_nop 0
    buffer_load_dwordx4 v8, s[88:91], s56 offen lds
    v_xor_b32 v16, 224, v10
    v_add_u32 v16, 98304, v16
    ds_read_b128 v[220:223], v16 offset:0
    ds_read_b64_tr_b16 v[92:93], v28 offset:14336
    ds_read_b64_tr_b16 v[94:95], v28 offset:14848
    s_waitcnt lgkmcnt(15)
    v_mfma_f32_32x32x16_bf16 v[32:47], v[200:203], v[72:75], v[32:47]
    s_add_u32 s54, s76, 50176
    s_max_u32 m0, s54, s95
    s_nop 0
    buffer_load_dwordx4 v9, s[88:91], s56 offen lds
    s_cmp_eq_u32 s7, 0
    s_cbranch_scc1 Lgw_18
    v_add_u32 v18, 53376, v24
    ds_write_b16 v18, v51
Lgw_18:
    s_waitcnt lgkmcnt(12)
    v_mfma_f32_32x32x16_bf16 v[32:47], v[204:207], v[76:79], v[32:47]
    s_waitcnt lgkmcnt(9)
    v_mfma_f32_32x32x16_bf16 v[32:47], v[208:211], v[80:83], v[32:47]
    s_waitcnt vmcnt(9) lgkmcnt(0)
    s_barrier
    s_cmp_lg_u32 s44, 7
    s_cbranch_scc1 Ltlb_19
    v_lshlrev_b32 v18, 20, v1
    s_mov_b64 exec, 0xffff
    buffer_load_dword v3, v18, s[28:31], 0 offen
    s_mov_b64 exec, 0xff
    v_lshlrev_b32 v18, 18, v1
    buffer_load_dword v4, v18, s[32:35], 0 offen
    s_mov_b64 exec, -1
Ltlb_19:
    v_xor_b32 v15, 0, v10
    ds_read_b128 v[224:227], v15 offset:0
    v_add_u32 v28, 147456, v11
    ds_read_b64_tr_b16 v[64:65], v28 offset:0
    ds_read_b64_tr_b16 v[66:67], v28 offset:512
    v_xor_b32 v16, 32, v10
    ds_read_b128 v[228:231], v16 offset:0
    ds_read_b64_tr_b16 v[68:69], v28 offset:2048
    ds_read_b64_tr_b16 v[70:71], v28 offset:2560
    v_mfma_f32_32x32x16_bf16 v[32:47], v[212:215], v[84:87], v[32:47]
    s_mul_i32 s56, s87, 4
    s_add_u32 s56, s56, s5
    s_add_u32 s54, s76, 98304
    s_max_u32 m0, s54, s95
    s_nop 0
    buffer_load_dwordx4 v8, s[88:91], s56 offen lds
    v_xor_b32 v15, 64, v10
    ds_read_b128 v[232:235], v15 offset:0
    ds_read_b64_tr_b16 v[72:73], v28 offset:4096
    ds_read_b64_tr_b16 v[74:75], v28 offset:4608
    v_xor_b32 v16, 96, v10
    ds_read_b128 v[236:239], v16 offset:0
    ds_read_b64_tr_b16 v[76:77], v28 offset:6144
    ds_read_b64_tr_b16 v[78:79], v28 offset:6656
    v_mfma_f32_32x32x16_bf16 v[32:47], v[216:219], v[88:91], v[32:47]
    s_add_u32 s54, s76, 99328
    s_max_u32 m0, s54, s95
    s_nop 0
    buffer_load_dwordx4 v9, s[88:91], s56 offen lds
    s_cmp_eq_u32 s7, 0
    s_cbranch_scc1 Lgw_20
    v_add_u32 v18, 102528, v24
    ds_write_b16 v18, v52
Lgw_20:
    v_xor_b32 v15, 128, v10
    ds_read_b128 v[240:243], v15 offset:0
    ds_read_b64_tr_b16 v[80:81], v28 offset:8192
    ds_read_b64_tr_b16 v[82:83], v28 offset:8704
    v_mfma_f32_32x32x16_bf16 v[32:47], v[220:223], v[92:95], v[32:47]
    s_mul_i32 s56, s87, 5
    s_add_u32 s56, s56, s5
    s_add_u32 s54, s76, 114688
    s_max_u32 m0, s54, s95
    s_nop 0
    buffer_load_dwordx4 v8, s[88:91], s56 offen lds
    v_xor_b32 v16, 160, v10
    ds_read_b128 v[244:247], v16 offset:0
    ds_read_b64_tr_b16 v[84:85], v28 offset:10240
    ds_read_b64_tr_b16 v[86:87], v28 offset:10752
    s_waitcnt lgkmcnt(15)
    v_mfma_f32_32x32x16_bf16 v[32:47], v[224:227], v[64:67], v[32:47]
    s_add_u32 s54, s76, 115712
    s_max_u32 m0, s54, s95
    s_nop 0
    buffer_load_dwordx4 v9, s[88:91], s56 offen lds
    s_cmp_eq_u32 s7, 0
    s_cbranch_scc1 Lgw_21
    v_add_u32 v18, 118912, v24
    ds_write_b16 v18, v53
Lgw_21:
    v_xor_b32 v15, 192, v10
    ds_read_b128 v[248:251], v15 offset:0
    ds_read_b64_tr_b16 v[88:89], v28 offset:12288
    ds_read_b64_tr_b16 v[90:91], v28 offset:12800
    s_waitcnt lgkmcnt(15)
    v_mfma_f32_32x32x16_bf16 v[32:47], v[228:231], v[68:71], v[32:47]
    s_mul_i32 s56, s87, 6
    s_add_u32 s56, s56, s5
    s_add_u32 s54, s76, 131072
    s_max_u32 m0, s54, s95
    s_nop 0
    buffer_load_dwordx4 v8, s[88:91], s56 offen lds
    v_xor_b32 v16, 224, v10
    ds_read_b128 v[252:255], v16 offset:0
    ds_read_b64_tr_b16 v[92:93], v28 offset:14336
    ds_read_b64_tr_b16 v[94:95], v28 offset:14848
    s_waitcnt lgkmcnt(15)
    v_mfma_f32_32x32x16_bf16 v[32:47], v[232:235], v[72:75], v[32:47]
    s_add_u32 s54, s76, 132096
    s_max_u32 m0, s54, s95
    s_nop 0
    buffer_load_dwordx4 v9, s[88:91], s56 offen lds
    s_cmp_eq_u32 s7, 0
    s_cbranch_scc1 Lgw_22
    v_add_u32 v18, 135296, v24
    ds_write_b16 v18, v54
Lgw_22:
    s_waitcnt lgkmcnt(12)
    v_mfma_f32_32x32x16_bf16 v[32:47], v[236:239], v[76:79], v[32:47]
    s_waitcnt lgkmcnt(9)
    v_mfma_f32_32x32x16_bf16 v[32:47], v[240:243], v[80:83], v[32:47]
    s_waitcnt vmcnt(13) lgkmcnt(0)
    s_barrier
    v_add_u32 v28, 32768, v12
    v_add_u32 v15, 32768, v26
    ds_read_b64_tr_b16 v[64:65], v28
    ds_read_b64_tr_b16 v[66:67], v15
    ds_read_b64_tr_b16 v[68:69], v30 offset:32768
    ds_read_b64_tr_b16 v[70:71], v30 offset:33536
    v_mfma_f32_32x32x16_bf16 v[32:47], v[244:247], v[84:87], v[32:47]
    s_mul_i32 s56, s87, 7
    s_add_u32 s56, s56, s5
    s_add_u32 s54, s76, 147456
    s_max_u32 m0, s54, s95
    s_nop 0
    buffer_load_dwordx4 v8, s[88:91], s56 offen lds
    v_add_u32 v28, s93, v28
    v_add_u32 v15, s93, v15
    ds_read_b64_tr_b16 v[72:73], v28
    ds_read_b64_tr_b16 v[74:75], v15
    ds_read_b64_tr_b16 v[76:77], v30 offset:35840
    ds_read_b64_tr_b16 v[78:79], v30 offset:36608
    v_mfma_f32_32x32x16_bf16 v[32:47], v[248:251], v[88:91], v[32:47]
    s_add_u32 s54, s76, 148480
    s_max_u32 m0, s54, s95
    s_nop 0
    buffer_load_dwordx4 v9, s[88:91], s56 offen lds
    s_cmp_eq_u32 s7, 0
    s_cbranch_scc1 Lgw_23
    v_add_u32 v18, 151680, v24
    ds_write_b16 v18, v55
Lgw_23:
    v_add_u32 v28, s93, v28
    v_add_u32 v15, s93, v15
    ds_read_b64_tr_b16 v[80:81], v28
    ds_read_b64_tr_b16 v[82:83], v15
    v_mfma_f32_32x32x16_bf16 v[32:47], v[252:255], v[92:95], v[32:47]
L_s1w:
    ds_read_b64_tr_b16 v[84:85], v30 offset:38912
    ds_read_b64_tr_b16 v[86:87], v30 offset:39680
    s_waitcnt lgkmcnt(10)
    v_mfma_f32_32x32x16_bf16 v[96:111], v[64:67], v[128:131], 0
    v_add_u32 v28, s93, v28
    v_add_u32 v15, s93, v15
    ds_read_b64_tr_b16 v[88:89], v28
    ds_read_b64_tr_b16 v[90:91], v15
    s_waitcnt lgkmcnt(10)
    v_mfma_f32_32x32x16_bf16 v[112:127], v[68:71], v[128:131], 0
    s_nop 7
    v_cvt_pk_bf16_f32 v32, v32, v33
    v_cvt_pk_bf16_f32 v33, v34, v35
    v_cvt_pk_bf16_f32 v34, v36, v37
    v_cvt_pk_bf16_f32 v35, v38, v39
    v_cvt_pk_bf16_f32 v36, v40, v41
    v_cvt_pk_bf16_f32 v37, v42, v43
    v_cvt_pk_bf16_f32 v38, v44, v45
    v_cvt_pk_bf16_f32 v39, v46, v47
    buffer_store_dwordx4 v[32:35], v2, s[28:31], s62 offen sc1
    buffer_store_dwordx4 v[36:39], v2, s[28:31], s62 offen offset:1024 sc1
    ds_read_b64_tr_b16 v[92:93], v30 offset:41984
    ds_read_b64_tr_b16 v[94:95], v30 offset:42752
    s_waitcnt lgkmcnt(10)
    v_mfma_f32_32x32x16_bf16 v[96:111], v[72:75], v[132:135], v[96:111]
    s_waitcnt vmcnt(14)
    s_barrier
    v_add_u32 v28, 65536, v12
    v_add_u32 v15, 65536, v26
    ds_read_b64_tr_b16 v[64:65], v28
    ds_read_b64_tr_b16 v[66:67], v15
    s_waitcnt lgkmcnt(10)
    v_mfma_f32_32x32x16_bf16 v[112:127], v[76:79], v[132:135], v[112:127]
    s_add_u32 s54, s65, 0
    s_add_u32 m0, s76, 0
    s_nop 0
    buffer_load_dwordx4 v14, s[20:23], s54 offen lds
    v_add_u32 v29, 65536, v30
    ds_read_b64_tr_b16 v[68:69], v29 offset:0
    ds_read_b64_tr_b16 v[70:71], v29 offset:768
    s_waitcnt lgkmcnt(10)
    v_mfma_f32_32x32x16_bf16 v[96:111], v[80:83], v[136:139], v[96:111]
    s_add_u32 s54, s65, 8192
    s_add_u32 m0, s76, 1024
    s_nop 0
    buffer_load_dwordx4 v14, s[20:23], s54 offen lds
    v_add_u32 v28, s93, v28
    v_add_u32 v15, s93, v15
    ds_read_b64_tr_b16 v[72:73], v28
    ds_read_b64_tr_b16 v[74:75], v15
    s_waitcnt lgkmcnt(10)
    v_mfma_f32_32x32x16_bf16 v[112:127], v[84:87], v[136:139], v[112:127]
    s_add_u32 s54, s65, 131072
    s_add_u32 m0, s76, 16384
    s_nop 0
    buffer_load_dwordx4 v14, s[20:23], s54 offen lds
    ds_read_b64_tr_b16 v[76:77], v29 offset:3072
    ds_read_b64_tr_b16 v[78:79], v29 offset:3840
    s_waitcnt lgkmcnt(10)
    v_mfma_f32_32x32x16_bf16 v[96:111], v[88:91], v[140:143], v[96:111]
    s_add_u32 s54, s65, 139264
    s_add_u32 m0, s76, 17408
    s_nop 0
    buffer_load_dwordx4 v14, s[20:23], s54 offen lds
    v_add_u32 v28, s93, v28
    v_add_u32 v15, s93, v15
    ds_read_b64_tr_b16 v[80:81], v28
    ds_read_b64_tr_b16 v[82:83], v15
    s_waitcnt lgkmcnt(10)
    v_mfma_f32_32x32x16_bf16 v[112:127], v[92:95], v[140:143], v[112:127]
    ds_read_b64_tr_b16 v[84:85], v29 offset:6144
    ds_read_b64_tr_b16 v[86:87], v29 offset:6912
    s_waitcnt lgkmcnt(10)
    v_mfma_f32_32x32x16_bf16 v[96:111], v[64:67], v[144:147], v[96:111]
    v_add_u32 v28, s93, v28
    v_add_u32 v15, s93, v15
    ds_read_b64_tr_b16 v[88:89], v28
    ds_read_b64_tr_b16 v[90:91], v15
    s_waitcnt lgkmcnt(10)
    v_mfma_f32_32x32x16_bf16 v[112:127], v[68:71], v[144:147], v[112:127]
    ds_read_b64_tr_b16 v[92:93], v29 offset:9216
    ds_read_b64_tr_b16 v[94:95], v29 offset:9984
    s_waitcnt lgkmcnt(10)
    v_mfma_f32_32x32x16_bf16 v[96:111], v[72:75], v[148:151], v[96:111]
    s_waitcnt vmcnt(4)
    s_barrier
    s_mov_b32 s67, 0
Lnp_24:
    v_readfirstlane_b32 s58, v20
    v_readfirstlane_b32 s59, v21
    s_nop 3
    s_cmp_lg_u32 s58, 0
    s_cbranch_scc1 Lnd_25
    s_sleep 2
    v_mov_b32 v18, 0
    buffer_load_dwordx2 v[20:21], v18, s[40:43], 0 offen sc1
    s_waitcnt vmcnt(0)
    s_add_u32 s67, s67, 1
    s_cmp_lt_u32 s67, 100000
    s_cbranch_scc1 Lnp_24
Lnd_25:
    s_cmp_lg_u32 s44, 0
    s_cbranch_scc1 Lsig_26
    v_mov_b32 v18, s58
    v_mov_b32 v19, s59
    v_mov_b32 v16, 0
    s_mov_b64 exec, 1
    buffer_store_dwordx2 v[18:19], v16, s[28:31], s6 offen sc1
    s_mov_b64 exec, -1
Lsig_26:
    v_add_u32 v28, 81920, v12
    v_add_u32 v15, 81920, v26
    ds_read_b64_tr_b16 v[64:65], v28
    ds_read_b64_tr_b16 v[66:67], v15
    s_waitcnt lgkmcnt(10)
    v_mfma_f32_32x32x16_bf16 v[112:127], v[76:79], v[148:151], v[112:127]
    s_add_u32 s54, s65, 262144
    s_add_u32 m0, s76, 32768
    s_nop 0
    buffer_load_dwordx4 v14, s[20:23], s54 offen lds
    v_add_u32 v29, 81920, v30
    ds_read_b64_tr_b16 v[68:69], v29 offset:0
    ds_read_b64_tr_b16 v[70:71], v29 offset:768
    s_waitcnt lgkmcnt(10)
    v_mfma_f32_32x32x16_bf16 v[96:111], v[80:83], v[152:155], v[96:111]
    s_add_u32 s54, s65, 270336
    s_add_u32 m0, s76, 33792
    s_nop 0
    buffer_load_dwordx4 v14, s[20:23], s54 offen lds
    v_add_u32 v28, s93, v28
    v_add_u32 v15, s93, v15
    ds_read_b64_tr_b16 v[72:73], v28
    ds_read_b64_tr_b16 v[74:75], v15
    s_waitcnt lgkmcnt(10)
    v_mfma_f32_32x32x16_bf16 v[112:127], v[84:87], v[152:155], v[112:127]
    ds_read_b64_tr_b16 v[76:77], v29 offset:3072
    ds_read_b64_tr_b16 v[78:79], v29 offset:3840
    s_waitcnt lgkmcnt(10)
    v_mfma_f32_32x32x16_bf16 v[96:111], v[88:91], v[156:159], v[96:111]
    v_add_u32 v28, s93, v28
    v_add_u32 v15, s93, v15
    ds_read_b64_tr_b16 v[80:81], v28
    ds_read_b64_tr_b16 v[82:83], v15
    s_waitcnt lgkmcnt(10)
    v_mfma_f32_32x32x16_bf16 v[112:127], v[92:95], v[156:159], v[112:127]
    ds_read_b64_tr_b16 v[84:85], v29 offset:6144
    ds_read_b64_tr_b16 v[86:87], v29 offset:6912
    s_waitcnt lgkmcnt(10)
    v_mfma_f32_32x32x16_bf16 v[96:111], v[64:67], v[160:163], v[96:111]
    v_add_u32 v28, s93, v28
    v_add_u32 v15, s93, v15
    ds_read_b64_tr_b16 v[88:89], v28
    ds_read_b64_tr_b16 v[90:91], v15
    s_waitcnt lgkmcnt(10)
    v_mfma_f32_32x32x16_bf16 v[112:127], v[68:71], v[160:163], v[112:127]
    ds_read_b64_tr_b16 v[92:93], v29 offset:9216
    ds_read_b64_tr_b16 v[94:95], v29 offset:9984
    s_waitcnt lgkmcnt(10)
    v_mfma_f32_32x32x16_bf16 v[96:111], v[72:75], v[164:167], v[96:111]
    s_barrier
    v_add_u32 v28, 49152, v12
    v_add_u32 v15, 49152, v26
    ds_read_b64_tr_b16 v[64:65], v28
    ds_read_b64_tr_b16 v[66:67], v15
    s_waitcnt lgkmcnt(10)
    v_mfma_f32_32x32x16_bf16 v[112:127], v[76:79], v[164:167], v[112:127]
    v_add_u32 v29, 49152, v30
    ds_read_b64_tr_b16 v[68:69], v29 offset:0
    ds_read_b64_tr_b16 v[70:71], v29 offset:768
    s_waitcnt lgkmcnt(10)
    v_mfma_f32_32x32x16_bf16 v[96:111], v[80:83], v[168:171], v[96:111]
    v_add_u32 v28, s93, v28
    v_add_u32 v15, s93, v15
    ds_read_b64_tr_b16 v[72:73], v28
    ds_read_b64_tr_b16 v[74:75], v15
    s_waitcnt lgkmcnt(10)
    v_mfma_f32_32x32x16_bf16 v[112:127], v[84:87], v[168:171], v[112:127]
    ds_read_b64_tr_b16 v[76:77], v29 offset:3072
    ds_read_b64_tr_b16 v[78:79], v29 offset:3840
    s_waitcnt lgkmcnt(10)
    v_mfma_f32_32x32x16_bf16 v[96:111], v[88:91], v[172:175], v[96:111]
    v_add_u32 v28, s93, v28
    v_add_u32 v15, s93, v15
    ds_read_b64_tr_b16 v[80:81], v28
    ds_read_b64_tr_b16 v[82:83], v15
    s_waitcnt lgkmcnt(10)
    v_mfma_f32_32x32x16_bf16 v[112:127], v[92:95], v[172:175], v[112:127]
    ds_read_b64_tr_b16 v[84:85], v29 offset:6144
    ds_read_b64_tr_b16 v[86:87], v29 offset:6912
    s_waitcnt lgkmcnt(10)
    v_mfma_f32_32x32x16_bf16 v[96:111], v[64:67], v[176:179], v[96:111]
    v_add_u32 v28, s93, v28
    v_add_u32 v15, s93, v15
    ds_read_b64_tr_b16 v[88:89], v28
    ds_read_b64_tr_b16 v[90:91], v15
    s_waitcnt lgkmcnt(10)
    v_mfma_f32_32x32x16_bf16 v[112:127], v[68:71], v[176:179], v[112:127]
    ds_read_b64_tr_b16 v[92:93], v29 offset:9216
    ds_read_b64_tr_b16 v[94:95], v29 offset:9984
    s_waitcnt lgkmcnt(10)
    v_mfma_f32_32x32x16_bf16 v[96:111], v[72:75], v[180:183], v[96:111]
    s_barrier
    v_add_u32 v28, 98304, v12
    v_add_u32 v15, 98304, v26
    ds_read_b64_tr_b16 v[64:65], v28
    ds_read_b64_tr_b16 v[66:67], v15
    s_waitcnt lgkmcnt(10)
    v_mfma_f32_32x32x16_bf16 v[112:127], v[76:79], v[180:183], v[112:127]
    v_add_u32 v29, 98304, v30
    ds_read_b64_tr_b16 v[68:69], v29 offset:0
    ds_read_b64_tr_b16 v[70:71], v29 offset:768
    s_waitcnt lgkmcnt(10)
    v_mfma_f32_32x32x16_bf16 v[96:111], v[80:83], v[184:187], v[96:111]
    v_add_u32 v28, s93, v28
    v_add_u32 v15, s93, v15
    ds_read_b64_tr_b16 v[72:73], v28
    ds_read_b64_tr_b16 v[74:75], v15
    s_waitcnt lgkmcnt(10)
    v_mfma_f32_32x32x16_bf16 v[112:127], v[84:87], v[184:187], v[112:127]
    ds_read_b64_tr_b16 v[76:77], v29 offset:3072
    ds_read_b64_tr_b16 v[78:79], v29 offset:3840
    s_waitcnt lgkmcnt(10)
    v_mfma_f32_32x32x16_bf16 v[96:111], v[88:91], v[188:191], v[96:111]
    v_add_u32 v28, s93, v28
    v_add_u32 v15, s93, v15
    ds_read_b64_tr_b16 v[80:81], v28
    ds_read_b64_tr_b16 v[82:83], v15
    s_waitcnt lgkmcnt(10)
    v_mfma_f32_32x32x16_bf16 v[112:127], v[92:95], v[188:191], v[112:127]
    ds_read_b64_tr_b16 v[84:85], v29 offset:6144
    ds_read_b64_tr_b16 v[86:87], v29 offset:6912
    s_waitcnt lgkmcnt(10)
    v_mfma_f32_32x32x16_bf16 v[96:111], v[64:67], v[192:195], v[96:111]
    v_add_u32 v28, s93, v28
    v_add_u32 v15, s93, v15
    ds_read_b64_tr_b16 v[88:89], v28
    ds_read_b64_tr_b16 v[90:91], v15
    s_waitcnt lgkmcnt(10)
    v_mfma_f32_32x32x16_bf16 v[112:127], v[68:71], v[192:195], v[112:127]
    ds_read_b64_tr_b16 v[92:93], v29 offset:9216
    ds_read_b64_tr_b16 v[94:95], v29 offset:9984
    s_waitcnt lgkmcnt(10)
    v_mfma_f32_32x32x16_bf16 v[96:111], v[72:75], v[196:199], v[96:111]
    s_barrier
    buffer_load_dwordx2 v[22:23], v25, s[28:31], 0 offen sc1
    v_add_u32 v28, 114688, v12
    v_add_u32 v15, 114688, v26
    ds_read_b64_tr_b16 v[64:65], v28
    ds_read_b64_tr_b16 v[66:67], v15
    s_waitcnt lgkmcnt(10)
    v_mfma_f32_32x32x16_bf16 v[112:127], v[76:79], v[196:199], v[112:127]
    s_add_u32 s54, s65, 393216
    s_add_u32 m0, s76, 49152
    s_nop 0
    buffer_load_dwordx4 v14, s[20:23], s54 offen lds
    v_add_u32 v29, 114688, v30
    ds_read_b64_tr_b16 v[68:69], v29 offset:0
    ds_read_b64_tr_b16 v[70:71], v29 offset:768
    s_waitcnt lgkmcnt(10)
    v_mfma_f32_32x32x16_bf16 v[96:111], v[80:83], v[200:203], v[96:111]
    s_add_u32 s54, s65, 401408
    s_add_u32 m0, s76, 50176
    s_nop 0
    buffer_load_dwordx4 v14, s[20:23], s54 offen lds
    v_add_u32 v28, s93, v28
    v_add_u32 v15, s93, v15
    ds_read_b64_tr_b16 v[72:73], v28
    ds_read_b64_tr_b16 v[74:75], v15
    s_waitcnt lgkmcnt(10)
    v_mfma_f32_32x32x16_bf16 v[112:127], v[84:87], v[200:203], v[112:127]
    ds_read_b64_tr_b16 v[76:77], v29 offset:3072
    ds_read_b64_tr_b16 v[78:79], v29 offset:3840
    s_waitcnt lgkmcnt(10)
    v_mfma_f32_32x32x16_bf16 v[96:111], v[88:91], v[204:207], v[96:111]
    v_add_u32 v28, s93, v28
    v_add_u32 v15, s93, v15
    ds_read_b64_tr_b16 v[80:81], v28
    ds_read_b64_tr_b16 v[82:83], v15
    s_waitcnt lgkmcnt(10)
    v_mfma_f32_32x32x16_bf16 v[112:127], v[92:95], v[204:207], v[112:127]
    ds_read_b64_tr_b16 v[84:85], v29 offset:6144
    ds_read_b64_tr_b16 v[86:87], v29 offset:6912
    s_waitcnt lgkmcnt(10)
    v_mfma_f32_32x32x16_bf16 v[96:111], v[64:67], v[208:211], v[96:111]
    v_add_u32 v28, s93, v28
    v_add_u32 v15, s93, v15
    ds_read_b64_tr_b16 v[88:89], v28
    ds_read_b64_tr_b16 v[90:91], v15
    s_waitcnt lgkmcnt(10)
    v_mfma_f32_32x32x16_bf16 v[112:127], v[68:71], v[208:211], v[112:127]
    ds_read_b64_tr_b16 v[92:93], v29 offset:9216
    ds_read_b64_tr_b16 v[94:95], v29 offset:9984
    s_waitcnt lgkmcnt(10)
    v_mfma_f32_32x32x16_bf16 v[96:111], v[72:75], v[212:215], v[96:111]
    s_barrier
    v_add_u32 v28, 131072, v12
    v_add_u32 v15, 131072, v26
    ds_read_b64_tr_b16 v[64:65], v28
    ds_read_b64_tr_b16 v[66:67], v15
    s_waitcnt lgkmcnt(10)
    v_mfma_f32_32x32x16_bf16 v[112:127], v[76:79], v[212:215], v[112:127]
    v_add_u32 v29, 131072, v30
    ds_read_b64_tr_b16 v[68:69], v29 offset:0
    ds_read_b64_tr_b16 v[70:71], v29 offset:768
    s_waitcnt lgkmcnt(10)
    v_mfma_f32_32x32x16_bf16 v[96:111], v[80:83], v[216:219], v[96:111]
    v_add_u32 v28, s93, v28
    v_add_u32 v15, s93, v15
    ds_read_b64_tr_b16 v[72:73], v28
    ds_read_b64_tr_b16 v[74:75], v15
    s_waitcnt lgkmcnt(10)
    v_mfma_f32_32x32x16_bf16 v[112:127], v[84:87], v[216:219], v[112:127]
    ds_read_b64_tr_b16 v[76:77], v29 offset:3072
    ds_read_b64_tr_b16 v[78:79], v29 offset:3840
    s_waitcnt lgkmcnt(10)
    v_mfma_f32_32x32x16_bf16 v[96:111], v[88:91], v[220:223], v[96:111]
    v_add_u32 v28, s93, v28
    v_add_u32 v15, s93, v15
    ds_read_b64_tr_b16 v[80:81], v28
    ds_read_b64_tr_b16 v[82:83], v15
    s_waitcnt lgkmcnt(10)
    v_mfma_f32_32x32x16_bf16 v[112:127], v[92:95], v[220:223], v[112:127]
    ds_read_b64_tr_b16 v[84:85], v29 offset:6144
    ds_read_b64_tr_b16 v[86:87], v29 offset:6912
    s_waitcnt lgkmcnt(10)
    v_mfma_f32_32x32x16_bf16 v[96:111], v[64:67], v[224:227], v[96:111]
    v_add_u32 v28, s93, v28
    v_add_u32 v15, s93, v15
    ds_read_b64_tr_b16 v[88:89], v28
    ds_read_b64_tr_b16 v[90:91], v15
    s_waitcnt lgkmcnt(10)
    v_mfma_f32_32x32x16_bf16 v[112:127], v[68:71], v[224:227], v[112:127]
    ds_read_b64_tr_b16 v[92:93], v29 offset:9216
    ds_read_b64_tr_b16 v[94:95], v29 offset:9984
    s_waitcnt lgkmcnt(10)
    v_mfma_f32_32x32x16_bf16 v[96:111], v[72:75], v[228:231], v[96:111]
    s_barrier
    s_waitcnt vmcnt(2)
    v_cmp_eq_u32 s[72:73], s58, v22
    v_cmp_eq_u32 s[74:75], s59, v23
    s_nop 3
    s_and_b64 s[72:73], s[72:73], s[74:75]
    s_and_b64 s[72:73], s[72:73], s[70:71]
    s_cmp_eq_u64 s[72:73], s[70:71]
    s_cselect_b32 s85, 1, 0
    s_cbranch_scc1 Lkv2_27
    buffer_load_dwordx2 v[22:23], v25, s[28:31], 0 offen sc1
Lkv2_27:
    v_add_u32 v28, 147456, v12
    v_add_u32 v15, 147456, v26
    ds_read_b64_tr_b16 v[64:65], v28
    ds_read_b64_tr_b16 v[66:67], v15
    s_waitcnt lgkmcnt(10)
    v_mfma_f32_32x32x16_bf16 v[112:127], v[76:79], v[228:231], v[112:127]
    s_cmp_eq_u32 s85, 0
    s_cbranch_scc1 Lkvg_28
    s_mul_i32 s61, s44, 3072
    s_add_u32 s54, s3, 2080768
    s_add_u32 m0, s61, 98304
    s_nop 0
    buffer_load_dwordx4 v2, s[28:31], s54 offen sc1 lds
Lkvg_28:
    v_add_u32 v29, 147456, v30
    ds_read_b64_tr_b16 v[68:69], v29 offset:0
    ds_read_b64_tr_b16 v[70:71], v29 offset:768
    s_waitcnt lgkmcnt(10)
    v_mfma_f32_32x32x16_bf16 v[96:111], v[80:83], v[232:235], v[96:111]
    s_cmp_eq_u32 s85, 0
    s_cbranch_scc1 Lkvg_29
    s_mul_i32 s61, s44, 3072
    s_add_u32 s54, s3, 2081792
    s_add_u32 m0, s61, 99328
    s_nop 0
    buffer_load_dwordx4 v2, s[28:31], s54 offen sc1 lds
Lkvg_29:
    v_add_u32 v28, s93, v28
    v_add_u32 v15, s93, v15
    ds_read_b64_tr_b16 v[72:73], v28
    ds_read_b64_tr_b16 v[74:75], v15
    s_waitcnt lgkmcnt(10)
    v_mfma_f32_32x32x16_bf16 v[112:127], v[84:87], v[232:235], v[112:127]
    s_cmp_eq_u32 s85, 0
    s_cbranch_scc1 Lkvg_30
    s_mul_i32 s61, s44, 3072
    s_add_u32 s54, s3, 2082816
    s_add_u32 m0, s61, 100352
    s_nop 0
    buffer_load_dwordx4 v2, s[28:31], s54 offen sc1 lds
Lkvg_30:
    ds_read_b64_tr_b16 v[76:77], v29 offset:3072
    ds_read_b64_tr_b16 v[78:79], v29 offset:3840
    s_waitcnt lgkmcnt(10)
    v_mfma_f32_32x32x16_bf16 v[96:111], v[88:91], v[236:239], v[96:111]
    s_cmp_eq_u32 s85, 0
    s_cbranch_scc1 Lkvg_31
    s_mul_i32 s61, s44, 3072
    s_add_u32 s54, s3, 4177920
    s_add_u32 m0, s61, 65536
    s_nop 0
    buffer_load_dwordx4 v2, s[28:31], s54 offen sc1 lds
Lkvg_31:
    v_add_u32 v28, s93, v28
    v_add_u32 v15, s93, v15
    ds_read_b64_tr_b16 v[80:81], v28
    ds_read_b64_tr_b16 v[82:83], v15
    s_waitcnt lgkmcnt(10)
    v_mfma_f32_32x32x16_bf16 v[112:127], v[92:95], v[236:239], v[112:127]
    s_cmp_eq_u32 s85, 0
    s_cbranch_scc1 Lkvg_32
    s_mul_i32 s61, s44, 3072
    s_add_u32 s54, s3, 4178944
    s_add_u32 m0, s61, 66560
    s_nop 0
    buffer_load_dwordx4 v2, s[28:31], s54 offen sc1 lds
Lkvg_32:
    ds_read_b64_tr_b16 v[84:85], v29 offset:6144
    ds_read_b64_tr_b16 v[86:87], v29 offset:6912
    s_waitcnt lgkmcnt(10)
    v_mfma_f32_32x32x16_bf16 v[96:111], v[64:67], v[240:243], v[96:111]
    s_cmp_eq_u32 s85, 0
    s_cbranch_scc1 Lkvg_33
    s_mul_i32 s61, s44, 3072
    s_add_u32 s54, s3, 4179968
    s_add_u32 m0, s61, 67584
    s_nop 0
    buffer_load_dwordx4 v2, s[28:31], s54 offen sc1 lds
Lkvg_33:
    v_add_u32 v28, s93, v28
    v_add_u32 v15, s93, v15
    ds_read_b64_tr_b16 v[88:89], v28
    ds_read_b64_tr_b16 v[90:91], v15
    s_waitcnt lgkmcnt(10)
    v_mfma_f32_32x32x16_bf16 v[112:127], v[68:71], v[240:243], v[112:127]
    ds_read_b64_tr_b16 v[92:93], v29 offset:9216
    ds_read_b64_tr_b16 v[94:95], v29 offset:9984
    s_waitcnt lgkmcnt(10)
    v_mfma_f32_32x32x16_bf16 v[96:111], v[72:75], v[244:247], v[96:111]
    s_waitcnt lgkmcnt(8)
    v_mfma_f32_32x32x16_bf16 v[112:127], v[76:79], v[244:247], v[112:127]
    s_waitcnt lgkmcnt(6)
    v_mfma_f32_32x32x16_bf16 v[96:111], v[80:83], v[248:251], v[96:111]
    s_waitcnt lgkmcnt(4)
    v_mfma_f32_32x32x16_bf16 v[112:127], v[84:87], v[248:251], v[112:127]
    s_waitcnt lgkmcnt(2)
    v_mfma_f32_32x32x16_bf16 v[96:111], v[88:91], v[252:255], v[96:111]
    s_waitcnt lgkmcnt(0)
    v_mfma_f32_32x32x16_bf16 v[112:127], v[92:95], v[252:255], v[112:127]
    s_nop 7
    s_nop 3
    s_cmp_lg_u32 s46, 15
    s_cbranch_scc1 Lgate_34
    s_cmp_lg_u32 s50, 1
    s_cbranch_scc1 Lgate_34
    v_cvt_pk_bf16_f32 v16, v112, v112
    v_lshlrev_b32 v16, 16, v16
    v_mul_f32 v16, 0xbfb8aa3b, v16
    v_exp_f32 v16, v16
    s_nop 0
    v_add_f32 v16, 1.0, v16
    v_rcp_f32 v16, v16
    s_nop 0
    v_cvt_pk_bf16_f32 v16, v16, v16
    v_lshlrev_b32 v16, 16, v16
    v_lshlrev_b32 v15, 2, v1
    s_lshl_b32 s54, s45, 2
    s_add_u32 s54, s54, s49
    s_lshl_b32 s54, s54, 7
    s_add_u32 s54, s54, 14680064
    s_mov_b64 s[68:69], exec
    s_mov_b32 exec_lo, -1
    s_mov_b32 exec_hi, 0
    buffer_store_dword v16, v15, s[28:31], s54 offen sc1
    s_mov_b64 exec, s[68:69]
Lgate_34:
    v_cvt_pk_bf16_f32 v72, v112, v113
    v_cvt_pk_bf16_f32 v73, v114, v115
    v_cvt_pk_bf16_f32 v74, v116, v117
    v_cvt_pk_bf16_f32 v75, v118, v119
    v_cvt_pk_bf16_f32 v76, v120, v121
    v_cvt_pk_bf16_f32 v77, v122, v123
    v_cvt_pk_bf16_f32 v78, v124, v125
    v_cvt_pk_bf16_f32 v79, v126, v127
    v_pk_max_i16 v72, v72, 0
    v_pk_max_i16 v73, v73, 0
    v_pk_max_i16 v74, v74, 0
    v_pk_max_i16 v75, v75, 0
    v_pk_max_i16 v76, v76, 0
    v_pk_max_i16 v77, v77, 0
    v_pk_max_i16 v78, v78, 0
    v_pk_max_i16 v79, v79, 0
    buffer_store_dwordx4 v[72:75], v2, s[28:31], s92 offen sc1
    buffer_store_dwordx4 v[76:79], v2, s[28:31], s92 offen offset:1024 sc1
    v_cvt_pk_bf16_f32 v64, v96, v97
    v_cvt_pk_bf16_f32 v65, v98, v99
    v_cvt_pk_bf16_f32 v66, v100, v101
    v_cvt_pk_bf16_f32 v67, v102, v103
    v_cvt_pk_bf16_f32 v68, v104, v105
    v_cvt_pk_bf16_f32 v69, v106, v107
    v_cvt_pk_bf16_f32 v70, v108, v109
    v_cvt_pk_bf16_f32 v71, v110, v111
    s_cmp_eq_u32 s50, 0
    s_cbranch_scc1 Lq_35
    v_pk_max_i16 v64, v64, 0
    v_pk_max_i16 v65, v65, 0
    v_pk_max_i16 v66, v66, 0
    v_pk_max_i16 v67, v67, 0
    v_pk_max_i16 v68, v68, 0
    v_pk_max_i16 v69, v69, 0
    v_pk_max_i16 v70, v70, 0
    v_pk_max_i16 v71, v71, 0
Lq_35:
    buffer_store_dwordx4 v[64:67], v2, s[28:31], s63 offen sc1
    buffer_store_dwordx4 v[68:71], v2, s[28:31], s63 offen offset:1024 sc1
    s_lshl_b32 s54, s49, 10
    s_add_u32 s54, s54, 122880
    v_add_u32 v15, s54, v2
    s_cmp_lg_u32 s50, 0
    s_cbranch_scc1 Lqx_37
    ds_write_b128 v15, v[68:71]
    v_mov_b32 v212, v64
    v_mov_b32 v213, v65
    v_mov_b32 v214, v66
    v_mov_b32 v215, v67
Lqx_37:
    s_cmp_lg_u32 s85, 0
    s_cbranch_scc1 Lkvok_38
    s_waitcnt vmcnt(0)
    v_cmp_eq_u32 s[72:73], s58, v22
    v_cmp_eq_u32 s[74:75], s59, v23
    s_nop 3
    s_and_b64 s[72:73], s[72:73], s[74:75]
    s_and_b64 s[72:73], s[72:73], s[70:71]
    s_cmp_eq_u64 s[72:73], s[70:71]
    s_cbranch_scc1 Lkv3_39
    s_mov_b32 s67, 0
Lpoll_40:
    buffer_load_dwordx2 v[18:19], v25, s[28:31], 0 offen sc1
    s_waitcnt vmcnt(0)
    v_cmp_eq_u32 s[72:73], s58, v18
    v_cmp_eq_u32 s[74:75], s59, v19
    s_nop 3
    s_and_b64 s[72:73], s[72:73], s[74:75]
    s_and_b64 s[72:73], s[72:73], s[70:71]
    s_cmp_eq_u64 s[72:73], s[70:71]
    s_cbranch_scc1 Lpolld_41
    s_sleep 1
    s_add_u32 s67, s67, 1
    s_cmp_lt_u32 s67, 100000
    s_cbranch_scc1 Lpoll_40
Lpolld_41:
Lkv3_39:
    s_mul_i32 s61, s44, 3072
    s_add_u32 s54, s3, 2080768
    s_add_u32 m0, s61, 98304
    s_nop 0
    buffer_load_dwordx4 v2, s[28:31], s54 offen sc1 lds
    s_mul_i32 s61, s44, 3072
    s_add_u32 s54, s3, 2081792
    s_add_u32 m0, s61, 99328
    s_nop 0
    buffer_load_dwordx4 v2, s[28:31], s54 offen sc1 lds
    s_mul_i32 s61, s44, 3072
    s_add_u32 s54, s3, 2082816
    s_add_u32 m0, s61, 100352
    s_nop 0
    buffer_load_dwordx4 v2, s[28:31], s54 offen sc1 lds
    s_mul_i32 s61, s44, 3072
    s_add_u32 s54, s3, 4177920
    s_add_u32 m0, s61, 65536
    s_nop 0
    buffer_load_dwordx4 v2, s[28:31], s54 offen sc1 lds
    s_mul_i32 s61, s44, 3072
    s_add_u32 s54, s3, 4178944
    s_add_u32 m0, s61, 66560
    s_nop 0
    buffer_load_dwordx4 v2, s[28:31], s54 offen sc1 lds
    s_mul_i32 s61, s44, 3072
    s_add_u32 s54, s3, 4179968
    s_add_u32 m0, s61, 67584
    s_nop 0
    buffer_load_dwordx4 v2, s[28:31], s54 offen sc1 lds
    s_waitcnt vmcnt(0)
Lkvok_38:
    s_cmp_eq_u32 s7, 0
    s_cbranch_scc1 Lgm_42
    v_and_b32 v18, 31, v1
    v_lshlrev_b32 v19, 2, v17
    v_sub_u32 v18, v18, v19
    v_mov_b32 v19, 0xf149f2ca
    v_cmp_gt_i32 vcc, 0, v18
    s_nop 1
    v_cndmask_b32 v48, 0, v19, vcc
    v_cmp_gt_i32 vcc, 1, v18
    s_nop 1
    v_cndmask_b32 v49, 0, v19, vcc
    v_cmp_gt_i32 vcc, 2, v18
    s_nop 1
    v_cndmask_b32 v50, 0, v19, vcc
    v_cmp_gt_i32 vcc, 3, v18
    s_nop 1
    v_cndmask_b32 v51, 0, v19, vcc
    v_cmp_gt_i32 vcc, 8, v18
    s_nop 1
    v_cndmask_b32 v52, 0, v19, vcc
    v_cmp_gt_i32 vcc, 9, v18
    s_nop 1
    v_cndmask_b32 v53, 0, v19, vcc
    v_cmp_gt_i32 vcc, 10, v18
    s_nop 1
    v_cndmask_b32 v54, 0, v19, vcc
    v_cmp_gt_i32 vcc, 11, v18
    s_nop 1
    v_cndmask_b32 v55, 0, v19, vcc
    v_cmp_gt_i32 vcc, 16, v18
    s_nop 1
    v_cndmask_b32 v56, 0, v19, vcc
    v_cmp_gt_i32 vcc, 17, v18
    s_nop 1
    v_cndmask_b32 v57, 0, v19, vcc
    v_cmp_gt_i32 vcc, 18, v18
    s_nop 1
    v_cndmask_b32 v58, 0, v19, vcc
    v_cmp_gt_i32 vcc, 19, v18
    s_nop 1
    v_cndmask_b32 v59, 0, v19, vcc
    v_cmp_gt_i32 vcc, 24, v18
    s_nop 1
    v_cndmask_b32 v60, 0, v19, vcc
    v_cmp_gt_i32 vcc, 25, v18
    s_nop 1
    v_cndmask_b32 v61, 0, v19, vcc
    v_cmp_gt_i32 vcc, 26, v18
    s_nop 1
    v_cndmask_b32 v62, 0, v19, vcc
    v_cmp_gt_i32 vcc, 27, v18
    s_nop 1
    v_cndmask_b32 v63, 0, v19, vcc
Lgm_42:
    v_add_u32 v251, s4, v2
    v_mov_b32 v19, 0xf149f2ca
    v_sub_f32 v32, v19, v48
    v_sub_f32 v33, v19, v49
    v_sub_f32 v34, v19, v50
    v_sub_f32 v35, v19, v51
    v_sub_f32 v36, v19, v52
    v_sub_f32 v37, v19, v53
    v_sub_f32 v38, v19, v54
    v_sub_f32 v39, v19, v55
    v_sub_f32 v40, v19, v56
    v_sub_f32 v41, v19, v57
    v_sub_f32 v42, v19, v58
    v_sub_f32 v43, v19, v59
    v_sub_f32 v44, v19, v60
    v_sub_f32 v45, v19, v61
    v_sub_f32 v46, v19, v62
    v_sub_f32 v47, v19, v63
    s_waitcnt vmcnt(4) lgkmcnt(0)
    s_barrier
    s_cmp_eq_u32 s50, 0
    s_cbranch_scc1 Lqr_43
    ds_read_b128 v[212:215], v15
Lqr_43:
    ds_read_b128 v[208:211], v251 offset:16384
    ds_read_b128 v[204:207], v251 offset:14336
    ds_read_b128 v[200:203], v251 offset:12288
    ds_read_b128 v[196:199], v251 offset:10240
    ds_read_b128 v[192:195], v251 offset:8192
    ds_read_b128 v[188:191], v251 offset:6144
    ds_read_b128 v[184:187], v251 offset:4096
    ds_read_b128 v[180:183], v251 offset:2048
    ds_read_b128 v[176:179], v251 offset:0
    s_waitcnt lgkmcnt(8)
    v_mfma_f32_32x32x16_bf16 v[48:63], v[208:211], v[212:215], v[48:63]
    v_mov_b32 v216, 0x3f803f80
    v_mov_b32 v217, 0x3f803f80
    v_mov_b32 v218, 0x3f803f80
    s_add_u32 s54, s65, 524288
    s_add_u32 m0, s76, 131072
    s_nop 0
    buffer_load_dwordx4 v14, s[20:23], s54 offen lds
    s_waitcnt lgkmcnt(7)
    v_mfma_f32_32x32x16_bf16 v[160:175], v[204:207], v[212:215], 0
    v_mov_b32 v219, 0x3f803f80
    v_mov_b32 v220, 0x3f803f80
    v_mov_b32 v221, 0x3f803f80
    s_waitcnt lgkmcnt(6)
    v_mfma_f32_32x32x16_bf16 v[144:159], v[200:203], v[212:215], 0
    v_mov_b32 v222, 0x3f803f80
    v_mov_b32 v223, 0x3f803f80
    v_mov_b32 v224, 0x3f803f80
    s_add_u32 s54, s65, 532480
    s_add_u32 m0, s76, 132096
    s_nop 0
    buffer_load_dwordx4 v14, s[20:23], s54 offen lds
    s_waitcnt lgkmcnt(5)
    v_mfma_f32_32x32x16_bf16 v[128:143], v[196:199], v[212:215], 0
    v_mov_b32 v225, 0x3f803f80
    v_mov_b32 v226, 0x3f803f80
    v_mov_b32 v227, 0x3f803f80
    s_waitcnt lgkmcnt(4)
    v_mfma_f32_32x32x16_bf16 v[112:127], v[192:195], v[212:215], 0
    v_mov_b32 v228, 0x3f803f80
    v_mov_b32 v229, 0x3f803f80
    v_mov_b32 v230, 0x3f803f80
    s_add_u32 s54, s65, 655360
    s_add_u32 m0, s76, 147456
    s_nop 0
    buffer_load_dwordx4 v14, s[20:23], s54 offen lds
    s_waitcnt lgkmcnt(3)
    v_mfma_f32_32x32x16_bf16 v[96:111], v[188:191], v[212:215], 0
    v_mov_b32 v231, 0x3f803f80
    v_mov_b32 v20, 0x3eb8aa3b
    v_mov_b32 v21, 0x3eb8aa3b
    s_waitcnt lgkmcnt(2)
    v_mfma_f32_32x32x16_bf16 v[80:95], v[184:187], v[212:215], 0
    v_add_u32 v250, s98, v2
    s_add_u32 s54, s65, 663552
    s_add_u32 m0, s76, 148480
    s_nop 0
    buffer_load_dwordx4 v14, s[20:23], s54 offen lds
    s_waitcnt lgkmcnt(1)
    v_mfma_f32_32x32x16_bf16 v[64:79], v[180:183], v[212:215], 0
    s_waitcnt lgkmcnt(0)
    v_mfma_f32_32x32x16_bf16 v[32:47], v[176:179], v[212:215], v[32:47]
    s_waitcnt vmcnt(4)
    v_mov_b32 v18, s58
    v_mov_b32 v19, s59
    v_mov_b32 v16, 0
    s_mov_b64 exec, 1
    buffer_store_dwordx2 v[18:19], v16, s[28:31], s99 offen sc1
    s_mov_b64 exec, -1
    s_nop 4
    v_max_f32 v248, v48, v49
    v_max3_f32 v248, v50, v51, v248
    v_max3_f32 v248, v52, v53, v248
    v_max3_f32 v248, v54, v55, v248
    v_max3_f32 v248, v56, v57, v248
    v_max3_f32 v248, v58, v59, v248
    v_max3_f32 v248, v60, v61, v248
    v_max3_f32 v248, v62, v63, v248
    s_cmp_gt_u32 s64, 7
    s_cbranch_scc1 Lmaxd_44
    v_max3_f32 v248, v160, v161, v248
    v_max3_f32 v248, v162, v163, v248
    v_max3_f32 v248, v164, v165, v248
    v_max3_f32 v248, v166, v167, v248
    v_max3_f32 v248, v168, v169, v248
    v_max3_f32 v248, v170, v171, v248
    v_max3_f32 v248, v172, v173, v248
    v_max3_f32 v248, v174, v175, v248
    s_cmp_gt_u32 s64, 6
    s_cbranch_scc1 Lmaxd_44
    v_max3_f32 v248, v144, v145, v248
    v_max3_f32 v248, v146, v147, v248
    v_max3_f32 v248, v148, v149, v248
    v_max3_f32 v248, v150, v151, v248
    v_max3_f32 v248, v152, v153, v248
    v_max3_f32 v248, v154, v155, v248
    v_max3_f32 v248, v156, v157, v248
    v_max3_f32 v248, v158, v159, v248
    s_cmp_gt_u32 s64, 5
    s_cbranch_scc1 Lmaxd_44
    v_max3_f32 v248, v128, v129, v248
    v_max3_f32 v248, v130, v131, v248
    v_max3_f32 v248, v132, v133, v248
    v_max3_f32 v248, v134, v135, v248
    v_max3_f32 v248, v136, v137, v248
    v_max3_f32 v248, v138, v139, v248
    v_max3_f32 v248, v140, v141, v248
    v_max3_f32 v248, v142, v143, v248
    s_cmp_gt_u32 s64, 4
    s_cbranch_scc1 Lmaxd_44
    v_max3_f32 v248, v112, v113, v248
    v_max3_f32 v248, v114, v115, v248
    v_max3_f32 v248, v116, v117, v248
    v_max3_f32 v248, v118, v119, v248
    v_max3_f32 v248, v120, v121, v248
    v_max3_f32 v248, v122, v123, v248
    v_max3_f32 v248, v124, v125, v248
    v_max3_f32 v248, v126, v127, v248
    s_cmp_gt_u32 s64, 3
    s_cbranch_scc1 Lmaxd_44
    v_max3_f32 v248, v96, v97, v248
    v_max3_f32 v248, v98, v99, v248
    v_max3_f32 v248, v100, v101, v248
    v_max3_f32 v248, v102, v103, v248
    v_max3_f32 v248, v104, v105, v248
    v_max3_f32 v248, v106, v107, v248
    v_max3_f32 v248, v108, v109, v248
    v_max3_f32 v248, v110, v111, v248
    s_cmp_gt_u32 s64, 2
    s_cbranch_scc1 Lmaxd_44
    v_max3_f32 v248, v80, v81, v248
    v_max3_f32 v248, v82, v83, v248
    v_max3_f32 v248, v84, v85, v248
    v_max3_f32 v248, v86, v87, v248
    v_max3_f32 v248, v88, v89, v248
    v_max3_f32 v248, v90, v91, v248
    v_max3_f32 v248, v92, v93, v248
    v_max3_f32 v248, v94, v95, v248
    s_cmp_gt_u32 s64, 1
    s_cbranch_scc1 Lmaxd_44
    v_max3_f32 v248, v64, v65, v248
    v_max3_f32 v248, v66, v67, v248
    v_max3_f32 v248, v68, v69, v248
    v_max3_f32 v248, v70, v71, v248
    v_max3_f32 v248, v72, v73, v248
    v_max3_f32 v248, v74, v75, v248
    v_max3_f32 v248, v76, v77, v248
    v_max3_f32 v248, v78, v79, v248
    s_cmp_gt_u32 s64, 0
    s_cbranch_scc1 Lmaxd_44
    v_max3_f32 v248, v32, v33, v248
    v_max3_f32 v248, v34, v35, v248
    v_max3_f32 v248, v36, v37, v248
    v_max3_f32 v248, v38, v39, v248
    v_max3_f32 v248, v40, v41, v248
    v_max3_f32 v248, v42, v43, v248
    v_max3_f32 v248, v44, v45, v248
    v_max3_f32 v248, v46, v47, v248
Lmaxd_44:
    v_mov_b32 v249, v248
    s_nop 1
    v_permlane32_swap_b32 v248, v249
    s_nop 1
    v_max_f32 v248, v248, v249
    v_mul_f32 v22, v20, v248
    v_sub_f32 v22, 0, v22
    v_mov_b32 v23, v22
    v_pk_fma_f32 v[48:49], v[48:49], v[20:21], v[22:23]
    v_pk_fma_f32 v[50:51], v[50:51], v[20:21], v[22:23]
    v_pk_fma_f32 v[52:53], v[52:53], v[20:21], v[22:23]
    v_pk_fma_f32 v[54:55], v[54:55], v[20:21], v[22:23]
    v_pk_fma_f32 v[56:57], v[56:57], v[20:21], v[22:23]
    v_pk_fma_f32 v[58:59], v[58:59], v[20:21], v[22:23]
    v_pk_fma_f32 v[60:61], v[60:61], v[20:21], v[22:23]
    v_pk_fma_f32 v[62:63], v[62:63], v[20:21], v[22:23]
    v_exp_f32 v48, v48
    v_exp_f32 v49, v49
    v_exp_f32 v50, v50
    v_exp_f32 v51, v51
    v_exp_f32 v52, v52
    v_exp_f32 v53, v53
    v_exp_f32 v54, v54
    v_exp_f32 v55, v55
    v_exp_f32 v56, v56
    v_exp_f32 v57, v57
    v_exp_f32 v58, v58
    v_exp_f32 v59, v59
    v_exp_f32 v60, v60
    v_exp_f32 v61, v61
    v_exp_f32 v62, v62
    v_exp_f32 v63, v63
    v_cvt_pk_bf16_f32 v48, v48, v49
    v_cvt_pk_bf16_f32 v49, v50, v51
    v_cvt_pk_bf16_f32 v50, v52, v53
    v_cvt_pk_bf16_f32 v51, v54, v55
    v_cvt_pk_bf16_f32 v52, v56, v57
    v_cvt_pk_bf16_f32 v53, v58, v59
    v_cvt_pk_bf16_f32 v54, v60, v61
    v_cvt_pk_bf16_f32 v55, v62, v63
    s_barrier
    s_add_u32 s54, s65, 786432
    s_add_u32 m0, s76, 98304
    s_nop 0
    buffer_load_dwordx4 v14, s[20:23], s54 offen lds
    s_add_u32 s54, s65, 794624
    s_add_u32 m0, s76, 99328
    s_nop 0
    buffer_load_dwordx4 v14, s[20:23], s54 offen lds
    s_add_u32 s54, s65, 917504
    s_add_u32 m0, s76, 114688
    s_nop 0
    buffer_load_dwordx4 v14, s[20:23], s54 offen lds
    s_add_u32 s54, s65, 925696
    s_add_u32 m0, s76, 115712
    s_nop 0
    buffer_load_dwordx4 v14, s[20:23], s54 offen lds
    s_mov_b64 exec, s[80:81]
    ds_read_b128 v[216:219], v250 offset:16384
    ds_read_b128 v[220:223], v250 offset:17408
    s_mov_b64 exec, -1
    s_mov_b32 s85, 0
    s_mov_b64 exec, s[80:81]
    ds_read_b128 v[224:227], v250 offset:14336
    ds_read_b128 v[228:231], v250 offset:15360
    s_mov_b64 exec, -1
    s_waitcnt lgkmcnt(2)
    s_nop 0
    v_mfma_f32_32x32x16_bf16 v[232:247], v[216:219], v[48:51], 0
    v_mfma_f32_32x32x16_bf16 v[232:247], v[220:223], v[52:55], v[232:247]
    s_cmp_gt_u32 s64, 7
    s_cbranch_scc1 Lskip_46
    s_mov_b64 exec, s[80:81]
    ds_read_b128 v[216:219], v250 offset:12288
    ds_read_b128 v[220:223], v250 offset:13312
    s_mov_b64 exec, -1
    v_pk_fma_f32 v[160:161], v[160:161], v[20:21], v[22:23]
    v_pk_fma_f32 v[162:163], v[162:163], v[20:21], v[22:23]
    v_pk_fma_f32 v[164:165], v[164:165], v[20:21], v[22:23]
    v_pk_fma_f32 v[166:167], v[166:167], v[20:21], v[22:23]
    v_pk_fma_f32 v[168:169], v[168:169], v[20:21], v[22:23]
    v_pk_fma_f32 v[170:171], v[170:171], v[20:21], v[22:23]
    v_pk_fma_f32 v[172:173], v[172:173], v[20:21], v[22:23]
    v_pk_fma_f32 v[174:175], v[174:175], v[20:21], v[22:23]
    v_exp_f32 v160, v160
    v_exp_f32 v161, v161
    v_exp_f32 v162, v162
    v_exp_f32 v163, v163
    v_exp_f32 v164, v164
    v_exp_f32 v165, v165
    v_exp_f32 v166, v166
    v_exp_f32 v167, v167
    v_exp_f32 v168, v168
    v_exp_f32 v169, v169
    v_exp_f32 v170, v170
    v_exp_f32 v171, v171
    v_exp_f32 v172, v172
    v_exp_f32 v173, v173
    v_exp_f32 v174, v174
    v_exp_f32 v175, v175
    v_cvt_pk_bf16_f32 v160, v160, v161
    v_cvt_pk_bf16_f32 v161, v162, v163
    v_cvt_pk_bf16_f32 v162, v164, v165
    v_cvt_pk_bf16_f32 v163, v166, v167
    v_cvt_pk_bf16_f32 v164, v168, v169
    v_cvt_pk_bf16_f32 v165, v170, v171
    v_cvt_pk_bf16_f32 v166, v172, v173
    v_cvt_pk_bf16_f32 v167, v174, v175
    s_waitcnt lgkmcnt(2)
    s_nop 0
    v_mfma_f32_32x32x16_bf16 v[232:247], v[224:227], v[160:163], v[232:247]
    v_mfma_f32_32x32x16_bf16 v[232:247], v[228:231], v[164:167], v[232:247]
    s_cmp_lg_u32 s85, 0
    s_cbranch_scc1 Lci_47
    buffer_load_dwordx4 v[252:255], v2, s[28:31], s100 offen sc1
Lci_47:
    s_cmp_gt_u32 s64, 6
    s_cbranch_scc1 Lskip_48
    s_mov_b64 exec, s[80:81]
    ds_read_b128 v[224:227], v250 offset:10240
    ds_read_b128 v[228:231], v250 offset:11264
    s_mov_b64 exec, -1
    v_pk_fma_f32 v[144:145], v[144:145], v[20:21], v[22:23]
    v_pk_fma_f32 v[146:147], v[146:147], v[20:21], v[22:23]
    v_pk_fma_f32 v[148:149], v[148:149], v[20:21], v[22:23]
    v_pk_fma_f32 v[150:151], v[150:151], v[20:21], v[22:23]
    v_pk_fma_f32 v[152:153], v[152:153], v[20:21], v[22:23]
    v_pk_fma_f32 v[154:155], v[154:155], v[20:21], v[22:23]
    v_pk_fma_f32 v[156:157], v[156:157], v[20:21], v[22:23]
    v_pk_fma_f32 v[158:159], v[158:159], v[20:21], v[22:23]
    v_exp_f32 v144, v144
    v_exp_f32 v145, v145
    v_exp_f32 v146, v146
    v_exp_f32 v147, v147
    v_exp_f32 v148, v148
    v_exp_f32 v149, v149
    v_exp_f32 v150, v150
    v_exp_f32 v151, v151
    v_exp_f32 v152, v152
    v_exp_f32 v153, v153
    v_exp_f32 v154, v154
    v_exp_f32 v155, v155
    v_exp_f32 v156, v156
    v_exp_f32 v157, v157
    v_exp_f32 v158, v158
    v_exp_f32 v159, v159
    v_cvt_pk_bf16_f32 v144, v144, v145
    v_cvt_pk_bf16_f32 v145, v146, v147
    v_cvt_pk_bf16_f32 v146, v148, v149
    v_cvt_pk_bf16_f32 v147, v150, v151
    v_cvt_pk_bf16_f32 v148, v152, v153
    v_cvt_pk_bf16_f32 v149, v154, v155
    v_cvt_pk_bf16_f32 v150, v156, v157
    v_cvt_pk_bf16_f32 v151, v158, v159
    s_waitcnt lgkmcnt(2)
    s_nop 0
    v_mfma_f32_32x32x16_bf16 v[232:247], v[216:219], v[144:147], v[232:247]
    v_mfma_f32_32x32x16_bf16 v[232:247], v[220:223], v[148:151], v[232:247]
    s_cmp_gt_u32 s64, 5
    s_cbranch_scc1 Lskip_49
    s_mov_b64 exec, s[80:81]
    ds_read_b128 v[216:219], v250 offset:8192
    ds_read_b128 v[220:223], v250 offset:9216
    s_mov_b64 exec, -1
    v_pk_fma_f32 v[128:129], v[128:129], v[20:21], v[22:23]
    v_pk_fma_f32 v[130:131], v[130:131], v[20:21], v[22:23]
    v_pk_fma_f32 v[132:133], v[132:133], v[20:21], v[22:23]
    v_pk_fma_f32 v[134:135], v[134:135], v[20:21], v[22:23]
    v_pk_fma_f32 v[136:137], v[136:137], v[20:21], v[22:23]
    v_pk_fma_f32 v[138:139], v[138:139], v[20:21], v[22:23]
    v_pk_fma_f32 v[140:141], v[140:141], v[20:21], v[22:23]
    v_pk_fma_f32 v[142:143], v[142:143], v[20:21], v[22:23]
    v_exp_f32 v128, v128
    v_exp_f32 v129, v129
    v_exp_f32 v130, v130
    v_exp_f32 v131, v131
    v_exp_f32 v132, v132
    v_exp_f32 v133, v133
    v_exp_f32 v134, v134
    v_exp_f32 v135, v135
    v_exp_f32 v136, v136
    v_exp_f32 v137, v137
    v_exp_f32 v138, v138
    v_exp_f32 v139, v139
    v_exp_f32 v140, v140
    v_exp_f32 v141, v141
    v_exp_f32 v142, v142
    v_exp_f32 v143, v143
    v_cvt_pk_bf16_f32 v128, v128, v129
    v_cvt_pk_bf16_f32 v129, v130, v131
    v_cvt_pk_bf16_f32 v130, v132, v133
    v_cvt_pk_bf16_f32 v131, v134, v135
    v_cvt_pk_bf16_f32 v132, v136, v137
    v_cvt_pk_bf16_f32 v133, v138, v139
    v_cvt_pk_bf16_f32 v134, v140, v141
    v_cvt_pk_bf16_f32 v135, v142, v143
    s_waitcnt lgkmcnt(2)
    s_nop 0
    v_mfma_f32_32x32x16_bf16 v[232:247], v[224:227], v[128:131], v[232:247]
    v_mfma_f32_32x32x16_bf16 v[232:247], v[228:231], v[132:135], v[232:247]
    s_cmp_lg_u32 s85, 0
    s_cbranch_scc1 Lch_50
    s_waitcnt vmcnt(0)
    v_xor_b32 v252, s58, v252
    v_xor_b32 v253, s59, v253
    v_xor_b32 v254, s58, v254
    v_xor_b32 v255, s59, v255
    v_or3_b32 v252, v252, v253, v254
    v_or_b32 v252, v252, v255
    v_cmp_ne_u32 vcc, 0, v252
    s_nop 3
    s_cmp_eq_u64 vcc, 0
    s_cselect_b32 s85, 1, 0
Lch_50:
    s_cmp_lg_u32 s85, 0
    s_cbranch_scc1 Lci_51
    buffer_load_dwordx4 v[252:255], v2, s[28:31], s100 offen sc1
Lci_51:
    s_cmp_lg_u32 s85, 1
    s_cbranch_scc1 Lhl_52
    s_add_u32 s54, s77, 0
    buffer_load_dwordx4 v[176:179], v2, s[28:31], s54 offen sc1
    s_add_u32 s54, s77, 4096
    buffer_load_dwordx4 v[180:183], v2, s[28:31], s54 offen sc1
    s_add_u32 s54, s77, 8192
    buffer_load_dwordx4 v[184:187], v2, s[28:31], s54 offen sc1
    s_add_u32 s54, s77, 12288
    buffer_load_dwordx4 v[188:191], v2, s[28:31], s54 offen sc1
Lhl_52:
    s_cmp_gt_u32 s64, 4
    s_cbranch_scc1 Lskip_53
    s_mov_b64 exec, s[80:81]
    ds_read_b128 v[224:227], v250 offset:6144
    ds_read_b128 v[228:231], v250 offset:7168
    s_mov_b64 exec, -1
    v_pk_fma_f32 v[112:113], v[112:113], v[20:21], v[22:23]
    v_pk_fma_f32 v[114:115], v[114:115], v[20:21], v[22:23]
    v_pk_fma_f32 v[116:117], v[116:117], v[20:21], v[22:23]
    v_pk_fma_f32 v[118:119], v[118:119], v[20:21], v[22:23]
    v_pk_fma_f32 v[120:121], v[120:121], v[20:21], v[22:23]
    v_pk_fma_f32 v[122:123], v[122:123], v[20:21], v[22:23]
    v_pk_fma_f32 v[124:125], v[124:125], v[20:21], v[22:23]
    v_pk_fma_f32 v[126:127], v[126:127], v[20:21], v[22:23]
    v_exp_f32 v112, v112
    v_exp_f32 v113, v113
    v_exp_f32 v114, v114
    v_exp_f32 v115, v115
    v_exp_f32 v116, v116
    v_exp_f32 v117, v117
    v_exp_f32 v118, v118
    v_exp_f32 v119, v119
    v_exp_f32 v120, v120
    v_exp_f32 v121, v121
    v_exp_f32 v122, v122
    v_exp_f32 v123, v123
    v_exp_f32 v124, v124
    v_exp_f32 v125, v125
    v_exp_f32 v126, v126
    v_exp_f32 v127, v127
    v_cvt_pk_bf16_f32 v112, v112, v113
    v_cvt_pk_bf16_f32 v113, v114, v115
    v_cvt_pk_bf16_f32 v114, v116, v117
    v_cvt_pk_bf16_f32 v115, v118, v119
    v_cvt_pk_bf16_f32 v116, v120, v121
    v_cvt_pk_bf16_f32 v117, v122, v123
    v_cvt_pk_bf16_f32 v118, v124, v125
    v_cvt_pk_bf16_f32 v119, v126, v127
    s_waitcnt lgkmcnt(2)
    s_nop 0
    v_mfma_f32_32x32x16_bf16 v[232:247], v[216:219], v[112:115], v[232:247]
    v_mfma_f32_32x32x16_bf16 v[232:247], v[220:223], v[116:119], v[232:247]
    s_cmp_lg_u32 s85, 1
    s_cbranch_scc1 Lhl_54
    s_add_u32 s54, s77, 16384
    buffer_load_dwordx4 v[192:195], v2, s[28:31], s54 offen sc1
    s_add_u32 s54, s77, 20480
    buffer_load_dwordx4 v[196:199], v2, s[28:31], s54 offen sc1
    s_add_u32 s54, s77, 24576
    buffer_load_dwordx4 v[200:203], v2, s[28:31], s54 offen sc1
    s_add_u32 s54, s77, 28672
    buffer_load_dwordx4 v[204:207], v2, s[28:31], s54 offen sc1
Lhl_54:
    s_cmp_gt_u32 s64, 3
    s_cbranch_scc1 Lskip_55
    s_mov_b64 exec, s[80:81]
    ds_read_b128 v[216:219], v250 offset:4096
    ds_read_b128 v[220:223], v250 offset:5120
    s_mov_b64 exec, -1
    v_pk_fma_f32 v[96:97], v[96:97], v[20:21], v[22:23]
    v_pk_fma_f32 v[98:99], v[98:99], v[20:21], v[22:23]
    v_pk_fma_f32 v[100:101], v[100:101], v[20:21], v[22:23]
    v_pk_fma_f32 v[102:103], v[102:103], v[20:21], v[22:23]
    v_pk_fma_f32 v[104:105], v[104:105], v[20:21], v[22:23]
    v_pk_fma_f32 v[106:107], v[106:107], v[20:21], v[22:23]
    v_pk_fma_f32 v[108:109], v[108:109], v[20:21], v[22:23]
    v_pk_fma_f32 v[110:111], v[110:111], v[20:21], v[22:23]
    v_exp_f32 v96, v96
    v_exp_f32 v97, v97
    v_exp_f32 v98, v98
    v_exp_f32 v99, v99
    v_exp_f32 v100, v100
    v_exp_f32 v101, v101
    v_exp_f32 v102, v102
    v_exp_f32 v103, v103
    v_exp_f32 v104, v104
    v_exp_f32 v105, v105
    v_exp_f32 v106, v106
    v_exp_f32 v107, v107
    v_exp_f32 v108, v108
    v_exp_f32 v109, v109
    v_exp_f32 v110, v110
    v_exp_f32 v111, v111
    v_cvt_pk_bf16_f32 v96, v96, v97
    v_cvt_pk_bf16_f32 v97, v98, v99
    v_cvt_pk_bf16_f32 v98, v100, v101
    v_cvt_pk_bf16_f32 v99, v102, v103
    v_cvt_pk_bf16_f32 v100, v104, v105
    v_cvt_pk_bf16_f32 v101, v106, v107
    v_cvt_pk_bf16_f32 v102, v108, v109
    v_cvt_pk_bf16_f32 v103, v110, v111
    s_waitcnt lgkmcnt(2)
    s_nop 0
    v_mfma_f32_32x32x16_bf16 v[232:247], v[224:227], v[96:99], v[232:247]
    v_mfma_f32_32x32x16_bf16 v[232:247], v[228:231], v[100:103], v[232:247]
    s_cmp_lg_u32 s85, 0
    s_cbranch_scc1 Lch_56
    s_waitcnt vmcnt(0)
    v_xor_b32 v252, s58, v252
    v_xor_b32 v253, s59, v253
    v_xor_b32 v254, s58, v254
    v_xor_b32 v255, s59, v255
    v_or3_b32 v252, v252, v253, v254
    v_or_b32 v252, v252, v255
    v_cmp_ne_u32 vcc, 0, v252
    s_nop 3
    s_cmp_eq_u64 vcc, 0
    s_cselect_b32 s85, 2, 0
Lch_56:
    s_cmp_lg_u32 s85, 0
    s_cbranch_scc1 Lci_57
    buffer_load_dwordx4 v[252:255], v2, s[28:31], s100 offen sc1
Lci_57:
    s_cmp_lg_u32 s85, 1
    s_cbranch_scc1 Lhl_58
    s_add_u32 s54, s77, 32768
    buffer_load_dwordx4 v[208:211], v2, s[28:31], s54 offen sc1
    s_add_u32 s54, s77, 36864
    buffer_load_dwordx4 v[212:215], v2, s[28:31], s54 offen sc1
    s_add_u32 s54, s77, 40960
    buffer_load_dwordx4 v[48:51], v2, s[28:31], s54 offen sc1
    s_add_u32 s54, s77, 45056
    buffer_load_dwordx4 v[52:55], v2, s[28:31], s54 offen sc1
Lhl_58:
    s_cmp_lg_u32 s85, 2
    s_cbranch_scc1 Lhl_59
    s_add_u32 s54, s77, 0
    buffer_load_dwordx4 v[176:179], v2, s[28:31], s54 offen sc1
    s_add_u32 s54, s77, 4096
    buffer_load_dwordx4 v[180:183], v2, s[28:31], s54 offen sc1
    s_add_u32 s54, s77, 8192
    buffer_load_dwordx4 v[184:187], v2, s[28:31], s54 offen sc1
    s_add_u32 s54, s77, 12288
    buffer_load_dwordx4 v[188:191], v2, s[28:31], s54 offen sc1
    s_add_u32 s54, s77, 16384
    buffer_load_dwordx4 v[192:195], v2, s[28:31], s54 offen sc1
    s_add_u32 s54, s77, 20480
    buffer_load_dwordx4 v[196:199], v2, s[28:31], s54 offen sc1
Lhl_59:
    s_cmp_gt_u32 s64, 2
    s_cbranch_scc1 Lskip_60
    s_mov_b64 exec, s[80:81]
    ds_read_b128 v[224:227], v250 offset:2048
    ds_read_b128 v[228:231], v250 offset:3072
    s_mov_b64 exec, -1
    v_pk_fma_f32 v[80:81], v[80:81], v[20:21], v[22:23]
    v_pk_fma_f32 v[82:83], v[82:83], v[20:21], v[22:23]
    v_pk_fma_f32 v[84:85], v[84:85], v[20:21], v[22:23]
    v_pk_fma_f32 v[86:87], v[86:87], v[20:21], v[22:23]
    v_pk_fma_f32 v[88:89], v[88:89], v[20:21], v[22:23]
    v_pk_fma_f32 v[90:91], v[90:91], v[20:21], v[22:23]
    v_pk_fma_f32 v[92:93], v[92:93], v[20:21], v[22:23]
    v_pk_fma_f32 v[94:95], v[94:95], v[20:21], v[22:23]
    v_exp_f32 v80, v80
    v_exp_f32 v81, v81
    v_exp_f32 v82, v82
    v_exp_f32 v83, v83
    v_exp_f32 v84, v84
    v_exp_f32 v85, v85
    v_exp_f32 v86, v86
    v_exp_f32 v87, v87
    v_exp_f32 v88, v88
    v_exp_f32 v89, v89
    v_exp_f32 v90, v90
    v_exp_f32 v91, v91
    v_exp_f32 v92, v92
    v_exp_f32 v93, v93
    v_exp_f32 v94, v94
    v_exp_f32 v95, v95
    v_cvt_pk_bf16_f32 v80, v80, v81
    v_cvt_pk_bf16_f32 v81, v82, v83
    v_cvt_pk_bf16_f32 v82, v84, v85
    v_cvt_pk_bf16_f32 v83, v86, v87
    v_cvt_pk_bf16_f32 v84, v88, v89
    v_cvt_pk_bf16_f32 v85, v90, v91
    v_cvt_pk_bf16_f32 v86, v92, v93
    v_cvt_pk_bf16_f32 v87, v94, v95
    s_waitcnt lgkmcnt(2)
    s_nop 0
    v_mfma_f32_32x32x16_bf16 v[232:247], v[216:219], v[80:83], v[232:247]
    v_mfma_f32_32x32x16_bf16 v[232:247], v[220:223], v[84:87], v[232:247]
    s_cmp_lg_u32 s85, 1
    s_cbranch_scc1 Lhl_61
    s_add_u32 s54, s77, 49152
    buffer_load_dwordx4 v[56:59], v2, s[28:31], s54 offen sc1
    s_add_u32 s54, s77, 53248
    buffer_load_dwordx4 v[60:63], v2, s[28:31], s54 offen sc1
    s_add_u32 s54, s77, 57344
    buffer_load_dwordx4 v[160:163], v2, s[28:31], s54 offen sc1
    s_add_u32 s54, s77, 61440
    buffer_load_dwordx4 v[164:167], v2, s[28:31], s54 offen sc1
Lhl_61:
    s_cmp_lg_u32 s85, 2
    s_cbranch_scc1 Lhl_62
    s_add_u32 s54, s77, 24576
    buffer_load_dwordx4 v[200:203], v2, s[28:31], s54 offen sc1
    s_add_u32 s54, s77, 28672
    buffer_load_dwordx4 v[204:207], v2, s[28:31], s54 offen sc1
    s_add_u32 s54, s77, 32768
    buffer_load_dwordx4 v[208:211], v2, s[28:31], s54 offen sc1
    s_add_u32 s54, s77, 36864
    buffer_load_dwordx4 v[212:215], v2, s[28:31], s54 offen sc1
    s_add_u32 s54, s77, 40960
    buffer_load_dwordx4 v[48:51], v2, s[28:31], s54 offen sc1
    s_add_u32 s54, s77, 45056
    buffer_load_dwordx4 v[52:55], v2, s[28:31], s54 offen sc1
Lhl_62:
    s_cmp_gt_u32 s64, 1
    s_cbranch_scc1 Lskip_63
    s_mov_b64 exec, s[80:81]
    ds_read_b128 v[216:219], v250 offset:0
    ds_read_b128 v[220:223], v250 offset:1024
    s_mov_b64 exec, -1
    v_pk_fma_f32 v[64:65], v[64:65], v[20:21], v[22:23]
    v_pk_fma_f32 v[66:67], v[66:67], v[20:21], v[22:23]
    v_pk_fma_f32 v[68:69], v[68:69], v[20:21], v[22:23]
    v_pk_fma_f32 v[70:71], v[70:71], v[20:21], v[22:23]
    v_pk_fma_f32 v[72:73], v[72:73], v[20:21], v[22:23]
    v_pk_fma_f32 v[74:75], v[74:75], v[20:21], v[22:23]
    v_pk_fma_f32 v[76:77], v[76:77], v[20:21], v[22:23]
    v_pk_fma_f32 v[78:79], v[78:79], v[20:21], v[22:23]
    v_exp_f32 v64, v64
    v_exp_f32 v65, v65
    v_exp_f32 v66, v66
    v_exp_f32 v67, v67
    v_exp_f32 v68, v68
    v_exp_f32 v69, v69
    v_exp_f32 v70, v70
    v_exp_f32 v71, v71
    v_exp_f32 v72, v72
    v_exp_f32 v73, v73
    v_exp_f32 v74, v74
    v_exp_f32 v75, v75
    v_exp_f32 v76, v76
    v_exp_f32 v77, v77
    v_exp_f32 v78, v78
    v_exp_f32 v79, v79
    v_cvt_pk_bf16_f32 v64, v64, v65
    v_cvt_pk_bf16_f32 v65, v66, v67
    v_cvt_pk_bf16_f32 v66, v68, v69
    v_cvt_pk_bf16_f32 v67, v70, v71
    v_cvt_pk_bf16_f32 v68, v72, v73
    v_cvt_pk_bf16_f32 v69, v74, v75
    v_cvt_pk_bf16_f32 v70, v76, v77
    v_cvt_pk_bf16_f32 v71, v78, v79
    s_waitcnt lgkmcnt(2)
    s_nop 0
    v_mfma_f32_32x32x16_bf16 v[232:247], v[224:227], v[64:67], v[232:247]
    v_mfma_f32_32x32x16_bf16 v[232:247], v[228:231], v[68:71], v[232:247]
    s_cmp_lg_u32 s85, 0
    s_cbranch_scc1 Lch_64
    s_waitcnt vmcnt(0)
    v_xor_b32 v252, s58, v252
    v_xor_b32 v253, s59, v253
    v_xor_b32 v254, s58, v254
    v_xor_b32 v255, s59, v255
    v_or3_b32 v252, v252, v253, v254
    v_or_b32 v252, v252, v255
    v_cmp_ne_u32 vcc, 0, v252
    s_nop 3
    s_cmp_eq_u64 vcc, 0
    s_cselect_b32 s85, 3, 0
Lch_64:
    s_cmp_lg_u32 s85, 1
    s_cbranch_scc1 Lhl_65
    s_add_u32 s54, s77, 65536
    buffer_load_dwordx4 v[168:171], v2, s[28:31], s54 offen sc1
    s_add_u32 s54, s77, 69632
    buffer_load_dwordx4 v[172:175], v2, s[28:31], s54 offen sc1
    s_add_u32 s54, s77, 73728
    buffer_load_dwordx4 v[144:147], v2, s[28:31], s54 offen sc1
    s_add_u32 s54, s77, 77824
    buffer_load_dwordx4 v[148:151], v2, s[28:31], s54 offen sc1
Lhl_65:
    s_cmp_lg_u32 s85, 2
    s_cbranch_scc1 Lhl_66
    s_add_u32 s54, s77, 49152
    buffer_load_dwordx4 v[56:59], v2, s[28:31], s54 offen sc1
    s_add_u32 s54, s77, 53248
    buffer_load_dwordx4 v[60:63], v2, s[28:31], s54 offen sc1
    s_add_u32 s54, s77, 57344
    buffer_load_dwordx4 v[160:163], v2, s[28:31], s54 offen sc1
    s_add_u32 s54, s77, 61440
    buffer_load_dwordx4 v[164:167], v2, s[28:31], s54 offen sc1
    s_add_u32 s54, s77, 65536
    buffer_load_dwordx4 v[168:171], v2, s[28:31], s54 offen sc1
    s_add_u32 s54, s77, 69632
    buffer_load_dwordx4 v[172:175], v2, s[28:31], s54 offen sc1
Lhl_66:
    s_cmp_lg_u32 s85, 3
    s_cbranch_scc1 Lhl_67
    s_add_u32 s54, s77, 0
    buffer_load_dwordx4 v[176:179], v2, s[28:31], s54 offen sc1
    s_add_u32 s54, s77, 4096
    buffer_load_dwordx4 v[180:183], v2, s[28:31], s54 offen sc1
    s_add_u32 s54, s77, 8192
    buffer_load_dwordx4 v[184:187], v2, s[28:31], s54 offen sc1
    s_add_u32 s54, s77, 12288
    buffer_load_dwordx4 v[188:191], v2, s[28:31], s54 offen sc1
    s_add_u32 s54, s77, 16384
    buffer_load_dwordx4 v[192:195], v2, s[28:31], s54 offen sc1
    s_add_u32 s54, s77, 20480
    buffer_load_dwordx4 v[196:199], v2, s[28:31], s54 offen sc1
    s_add_u32 s54, s77, 24576
    buffer_load_dwordx4 v[200:203], v2, s[28:31], s54 offen sc1
    s_add_u32 s54, s77, 28672
    buffer_load_dwordx4 v[204:207], v2, s[28:31], s54 offen sc1
    s_add_u32 s54, s77, 32768
    buffer_load_dwordx4 v[208:211], v2, s[28:31], s54 offen sc1
    s_add_u32 s54, s77, 36864
    buffer_load_dwordx4 v[212:215], v2, s[28:31], s54 offen sc1
    s_add_u32 s54, s77, 40960
    buffer_load_dwordx4 v[48:51], v2, s[28:31], s54 offen sc1
    s_add_u32 s54, s77, 45056
    buffer_load_dwordx4 v[52:55], v2, s[28:31], s54 offen sc1
Lhl_67:
    s_cmp_gt_u32 s64, 0
    s_cbranch_scc1 Lskip_68
    v_pk_fma_f32 v[32:33], v[32:33], v[20:21], v[22:23]
    v_pk_fma_f32 v[34:35], v[34:35], v[20:21], v[22:23]
    v_pk_fma_f32 v[36:37], v[36:37], v[20:21], v[22:23]
    v_pk_fma_f32 v[38:39], v[38:39], v[20:21], v[22:23]
    v_pk_fma_f32 v[40:41], v[40:41], v[20:21], v[22:23]
    v_pk_fma_f32 v[42:43], v[42:43], v[20:21], v[22:23]
    v_pk_fma_f32 v[44:45], v[44:45], v[20:21], v[22:23]
    v_pk_fma_f32 v[46:47], v[46:47], v[20:21], v[22:23]
    v_exp_f32 v32, v32
    v_exp_f32 v33, v33
    v_exp_f32 v34, v34
    v_exp_f32 v35, v35
    v_exp_f32 v36, v36
    v_exp_f32 v37, v37
    v_exp_f32 v38, v38
    v_exp_f32 v39, v39
    v_exp_f32 v40, v40
    v_exp_f32 v41, v41
    v_exp_f32 v42, v42
    v_exp_f32 v43, v43
    v_exp_f32 v44, v44
    v_exp_f32 v45, v45
    v_exp_f32 v46, v46
    v_exp_f32 v47, v47
    v_cvt_pk_bf16_f32 v32, v32, v33
    v_cvt_pk_bf16_f32 v33, v34, v35
    v_cvt_pk_bf16_f32 v34, v36, v37
    v_cvt_pk_bf16_f32 v35, v38, v39
    v_cvt_pk_bf16_f32 v36, v40, v41
    v_cvt_pk_bf16_f32 v37, v42, v43
    v_cvt_pk_bf16_f32 v38, v44, v45
    v_cvt_pk_bf16_f32 v39, v46, v47
    s_waitcnt lgkmcnt(0)
    s_nop 0
    v_mfma_f32_32x32x16_bf16 v[232:247], v[216:219], v[32:35], v[232:247]
    v_mfma_f32_32x32x16_bf16 v[232:247], v[220:223], v[36:39], v[232:247]
    s_cmp_lg_u32 s85, 1
    s_cbranch_scc1 Lhl_69
    s_add_u32 s54, s77, 81920
    buffer_load_dwordx4 v[152:155], v2, s[28:31], s54 offen sc1
    s_add_u32 s54, s77, 86016
    s_cmp_ge_u32 s49, 2
    s_cselect_b32 s54, 1073741824, s54
    buffer_load_dwordx4 v[156:159], v2, s[28:31], s54 offen sc1
    v_and_b32 v15, 31, v1
    v_lshlrev_b32 v15, 2, v15
    buffer_load_dword v24, v15, s[28:31], s86 offen sc1
Lhl_69:
    s_cmp_lg_u32 s85, 2
    s_cbranch_scc1 Lhl_70
    s_add_u32 s54, s77, 73728
    buffer_load_dwordx4 v[144:147], v2, s[28:31], s54 offen sc1
    s_add_u32 s54, s77, 77824
    buffer_load_dwordx4 v[148:151], v2, s[28:31], s54 offen sc1
    s_add_u32 s54, s77, 81920
    buffer_load_dwordx4 v[152:155], v2, s[28:31], s54 offen sc1
    s_add_u32 s54, s77, 86016
    s_cmp_ge_u32 s49, 2
    s_cselect_b32 s54, 1073741824, s54
    buffer_load_dwordx4 v[156:159], v2, s[28:31], s54 offen sc1
    v_and_b32 v15, 31, v1
    v_lshlrev_b32 v15, 2, v15
    buffer_load_dword v24, v15, s[28:31], s86 offen sc1
Lhl_70:
    s_cmp_lg_u32 s85, 3
    s_cbranch_scc1 Lhl_71
    s_add_u32 s54, s77, 49152
    buffer_load_dwordx4 v[56:59], v2, s[28:31], s54 offen sc1
    s_add_u32 s54, s77, 53248
    buffer_load_dwordx4 v[60:63], v2, s[28:31], s54 offen sc1
    s_add_u32 s54, s77, 57344
    buffer_load_dwordx4 v[160:163], v2, s[28:31], s54 offen sc1
    s_add_u32 s54, s77, 61440
    buffer_load_dwordx4 v[164:167], v2, s[28:31], s54 offen sc1
    s_add_u32 s54, s77, 65536
    buffer_load_dwordx4 v[168:171], v2, s[28:31], s54 offen sc1
    s_add_u32 s54, s77, 69632
    buffer_load_dwordx4 v[172:175], v2, s[28:31], s54 offen sc1
    s_add_u32 s54, s77, 73728
    buffer_load_dwordx4 v[144:147], v2, s[28:31], s54 offen sc1
    s_add_u32 s54, s77, 77824
    buffer_load_dwordx4 v[148:151], v2, s[28:31], s54 offen sc1
    s_add_u32 s54, s77, 81920
    buffer_load_dwordx4 v[152:155], v2, s[28:31], s54 offen sc1
    s_add_u32 s54, s77, 86016
    s_cmp_ge_u32 s49, 2
    s_cselect_b32 s54, 1073741824, s54
    buffer_load_dwordx4 v[156:159], v2, s[28:31], s54 offen sc1
    v_and_b32 v15, 31, v1
    v_lshlrev_b32 v15, 2, v15
    buffer_load_dword v24, v15, s[28:31], s86 offen sc1
Lhl_71:
    s_branch Lpvd_45
Lskip_46:
    s_cmp_lg_u32 s85, 0
    s_cbranch_scc1 Lci_72
    buffer_load_dwordx4 v[252:255], v2, s[28:31], s100 offen sc1
Lci_72:
Lskip_48:
Lskip_49:
    s_cmp_lg_u32 s85, 0
    s_cbranch_scc1 Lch_73
    s_waitcnt vmcnt(0)
    v_xor_b32 v252, s58, v252
    v_xor_b32 v253, s59, v253
    v_xor_b32 v254, s58, v254
    v_xor_b32 v255, s59, v255
    v_or3_b32 v252, v252, v253, v254
    v_or_b32 v252, v252, v255
    v_cmp_ne_u32 vcc, 0, v252
    s_nop 3
    s_cmp_eq_u64 vcc, 0
    s_cselect_b32 s85, 1, 0
Lch_73:
    s_cmp_lg_u32 s85, 0
    s_cbranch_scc1 Lci_74
    buffer_load_dwordx4 v[252:255], v2, s[28:31], s100 offen sc1
Lci_74:
    s_cmp_lg_u32 s85, 1
    s_cbranch_scc1 Lhl_75
    s_add_u32 s54, s77, 0
    buffer_load_dwordx4 v[176:179], v2, s[28:31], s54 offen sc1
    s_add_u32 s54, s77, 4096
    buffer_load_dwordx4 v[180:183], v2, s[28:31], s54 offen sc1
    s_add_u32 s54, s77, 8192
    buffer_load_dwordx4 v[184:187], v2, s[28:31], s54 offen sc1
    s_add_u32 s54, s77, 12288
    buffer_load_dwordx4 v[188:191], v2, s[28:31], s54 offen sc1
Lhl_75:
Lskip_53:
    s_cmp_lg_u32 s85, 1
    s_cbranch_scc1 Lhl_76
    s_add_u32 s54, s77, 16384
    buffer_load_dwordx4 v[192:195], v2, s[28:31], s54 offen sc1
    s_add_u32 s54, s77, 20480
    buffer_load_dwordx4 v[196:199], v2, s[28:31], s54 offen sc1
    s_add_u32 s54, s77, 24576
    buffer_load_dwordx4 v[200:203], v2, s[28:31], s54 offen sc1
    s_add_u32 s54, s77, 28672
    buffer_load_dwordx4 v[204:207], v2, s[28:31], s54 offen sc1
Lhl_76:
Lskip_55:
    s_cmp_lg_u32 s85, 0
    s_cbranch_scc1 Lch_77
    s_waitcnt vmcnt(0)
    v_xor_b32 v252, s58, v252
    v_xor_b32 v253, s59, v253
    v_xor_b32 v254, s58, v254
    v_xor_b32 v255, s59, v255
    v_or3_b32 v252, v252, v253, v254
    v_or_b32 v252, v252, v255
    v_cmp_ne_u32 vcc, 0, v252
    s_nop 3
    s_cmp_eq_u64 vcc, 0
    s_cselect_b32 s85, 2, 0
Lch_77:
    s_cmp_lg_u32 s85, 0
    s_cbranch_scc1 Lci_78
    buffer_load_dwordx4 v[252:255], v2, s[28:31], s100 offen sc1
Lci_78:
    s_cmp_lg_u32 s85, 1
    s_cbranch_scc1 Lhl_79
    s_add_u32 s54, s77, 32768
    buffer_load_dwordx4 v[208:211], v2, s[28:31], s54 offen sc1
    s_add_u32 s54, s77, 36864
    buffer_load_dwordx4 v[212:215], v2, s[28:31], s54 offen sc1
    s_add_u32 s54, s77, 40960
    buffer_load_dwordx4 v[48:51], v2, s[28:31], s54 offen sc1
    s_add_u32 s54, s77, 45056
    buffer_load_dwordx4 v[52:55], v2, s[28:31], s54 offen sc1
Lhl_79:
    s_cmp_lg_u32 s85, 2
    s_cbranch_scc1 Lhl_80
    s_add_u32 s54, s77, 0
    buffer_load_dwordx4 v[176:179], v2, s[28:31], s54 offen sc1
    s_add_u32 s54, s77, 4096
    buffer_load_dwordx4 v[180:183], v2, s[28:31], s54 offen sc1
    s_add_u32 s54, s77, 8192
    buffer_load_dwordx4 v[184:187], v2, s[28:31], s54 offen sc1
    s_add_u32 s54, s77, 12288
    buffer_load_dwordx4 v[188:191], v2, s[28:31], s54 offen sc1
    s_add_u32 s54, s77, 16384
    buffer_load_dwordx4 v[192:195], v2, s[28:31], s54 offen sc1
    s_add_u32 s54, s77, 20480
    buffer_load_dwordx4 v[196:199], v2, s[28:31], s54 offen sc1
Lhl_80:
Lskip_60:
    s_cmp_lg_u32 s85, 1
    s_cbranch_scc1 Lhl_81
    s_add_u32 s54, s77, 49152
    buffer_load_dwordx4 v[56:59], v2, s[28:31], s54 offen sc1
    s_add_u32 s54, s77, 53248
    buffer_load_dwordx4 v[60:63], v2, s[28:31], s54 offen sc1
    s_add_u32 s54, s77, 57344
    buffer_load_dwordx4 v[160:163], v2, s[28:31], s54 offen sc1
    s_add_u32 s54, s77, 61440
    buffer_load_dwordx4 v[164:167], v2, s[28:31], s54 offen sc1
Lhl_81:
    s_cmp_lg_u32 s85, 2
    s_cbranch_scc1 Lhl_82
    s_add_u32 s54, s77, 24576
    buffer_load_dwordx4 v[200:203], v2, s[28:31], s54 offen sc1
    s_add_u32 s54, s77, 28672
    buffer_load_dwordx4 v[204:207], v2, s[28:31], s54 offen sc1
    s_add_u32 s54, s77, 32768
    buffer_load_dwordx4 v[208:211], v2, s[28:31], s54 offen sc1
    s_add_u32 s54, s77, 36864
    buffer_load_dwordx4 v[212:215], v2, s[28:31], s54 offen sc1
    s_add_u32 s54, s77, 40960
    buffer_load_dwordx4 v[48:51], v2, s[28:31], s54 offen sc1
    s_add_u32 s54, s77, 45056
    buffer_load_dwordx4 v[52:55], v2, s[28:31], s54 offen sc1
Lhl_82:
Lskip_63:
    s_cmp_lg_u32 s85, 0
    s_cbranch_scc1 Lch_83
    s_waitcnt vmcnt(0)
    v_xor_b32 v252, s58, v252
    v_xor_b32 v253, s59, v253
    v_xor_b32 v254, s58, v254
    v_xor_b32 v255, s59, v255
    v_or3_b32 v252, v252, v253, v254
    v_or_b32 v252, v252, v255
    v_cmp_ne_u32 vcc, 0, v252
    s_nop 3
    s_cmp_eq_u64 vcc, 0
    s_cselect_b32 s85, 3, 0
Lch_83:
    s_cmp_lg_u32 s85, 1
    s_cbranch_scc1 Lhl_84
    s_add_u32 s54, s77, 65536
    buffer_load_dwordx4 v[168:171], v2, s[28:31], s54 offen sc1
    s_add_u32 s54, s77, 69632
    buffer_load_dwordx4 v[172:175], v2, s[28:31], s54 offen sc1
    s_add_u32 s54, s77, 73728
    buffer_load_dwordx4 v[144:147], v2, s[28:31], s54 offen sc1
    s_add_u32 s54, s77, 77824
    buffer_load_dwordx4 v[148:151], v2, s[28:31], s54 offen sc1
Lhl_84:
    s_cmp_lg_u32 s85, 2
    s_cbranch_scc1 Lhl_85
    s_add_u32 s54, s77, 49152
    buffer_load_dwordx4 v[56:59], v2, s[28:31], s54 offen sc1
    s_add_u32 s54, s77, 53248
    buffer_load_dwordx4 v[60:63], v2, s[28:31], s54 offen sc1
    s_add_u32 s54, s77, 57344
    buffer_load_dwordx4 v[160:163], v2, s[28:31], s54 offen sc1
    s_add_u32 s54, s77, 61440
    buffer_load_dwordx4 v[164:167], v2, s[28:31], s54 offen sc1
    s_add_u32 s54, s77, 65536
    buffer_load_dwordx4 v[168:171], v2, s[28:31], s54 offen sc1
    s_add_u32 s54, s77, 69632
    buffer_load_dwordx4 v[172:175], v2, s[28:31], s54 offen sc1
Lhl_85:
    s_cmp_lg_u32 s85, 3
    s_cbranch_scc1 Lhl_86
    s_add_u32 s54, s77, 0
    buffer_load_dwordx4 v[176:179], v2, s[28:31], s54 offen sc1
    s_add_u32 s54, s77, 4096
    buffer_load_dwordx4 v[180:183], v2, s[28:31], s54 offen sc1
    s_add_u32 s54, s77, 8192
    buffer_load_dwordx4 v[184:187], v2, s[28:31], s54 offen sc1
    s_add_u32 s54, s77, 12288
    buffer_load_dwordx4 v[188:191], v2, s[28:31], s54 offen sc1
    s_add_u32 s54, s77, 16384
    buffer_load_dwordx4 v[192:195], v2, s[28:31], s54 offen sc1
    s_add_u32 s54, s77, 20480
    buffer_load_dwordx4 v[196:199], v2, s[28:31], s54 offen sc1
    s_add_u32 s54, s77, 24576
    buffer_load_dwordx4 v[200:203], v2, s[28:31], s54 offen sc1
    s_add_u32 s54, s77, 28672
    buffer_load_dwordx4 v[204:207], v2, s[28:31], s54 offen sc1
    s_add_u32 s54, s77, 32768
    buffer_load_dwordx4 v[208:211], v2, s[28:31], s54 offen sc1
    s_add_u32 s54, s77, 36864
    buffer_load_dwordx4 v[212:215], v2, s[28:31], s54 offen sc1
    s_add_u32 s54, s77, 40960
    buffer_load_dwordx4 v[48:51], v2, s[28:31], s54 offen sc1
    s_add_u32 s54, s77, 45056
    buffer_load_dwordx4 v[52:55], v2, s[28:31], s54 offen sc1
Lhl_86:
Lskip_68:
    s_cmp_lg_u32 s85, 1
    s_cbranch_scc1 Lhl_87
    s_add_u32 s54, s77, 81920
    buffer_load_dwordx4 v[152:155], v2, s[28:31], s54 offen sc1
    s_add_u32 s54, s77, 86016
    s_cmp_ge_u32 s49, 2
    s_cselect_b32 s54, 1073741824, s54
    buffer_load_dwordx4 v[156:159], v2, s[28:31], s54 offen sc1
    v_and_b32 v15, 31, v1
    v_lshlrev_b32 v15, 2, v15
    buffer_load_dword v24, v15, s[28:31], s86 offen sc1
Lhl_87:
    s_cmp_lg_u32 s85, 2
    s_cbranch_scc1 Lhl_88
    s_add_u32 s54, s77, 73728
    buffer_load_dwordx4 v[144:147], v2, s[28:31], s54 offen sc1
    s_add_u32 s54, s77, 77824
    buffer_load_dwordx4 v[148:151], v2, s[28:31], s54 offen sc1
    s_add_u32 s54, s77, 81920
    buffer_load_dwordx4 v[152:155], v2, s[28:31], s54 offen sc1
    s_add_u32 s54, s77, 86016
    s_cmp_ge_u32 s49, 2
    s_cselect_b32 s54, 1073741824, s54
    buffer_load_dwordx4 v[156:159], v2, s[28:31], s54 offen sc1
    v_and_b32 v15, 31, v1
    v_lshlrev_b32 v15, 2, v15
    buffer_load_dword v24, v15, s[28:31], s86 offen sc1
Lhl_88:
    s_cmp_lg_u32 s85, 3
    s_cbranch_scc1 Lhl_89
    s_add_u32 s54, s77, 49152
    buffer_load_dwordx4 v[56:59], v2, s[28:31], s54 offen sc1
    s_add_u32 s54, s77, 53248
    buffer_load_dwordx4 v[60:63], v2, s[28:31], s54 offen sc1
    s_add_u32 s54, s77, 57344
    buffer_load_dwordx4 v[160:163], v2, s[28:31], s54 offen sc1
    s_add_u32 s54, s77, 61440
    buffer_load_dwordx4 v[164:167], v2, s[28:31], s54 offen sc1
    s_add_u32 s54, s77, 65536
    buffer_load_dwordx4 v[168:171], v2, s[28:31], s54 offen sc1
    s_add_u32 s54, s77, 69632
    buffer_load_dwordx4 v[172:175], v2, s[28:31], s54 offen sc1
    s_add_u32 s54, s77, 73728
    buffer_load_dwordx4 v[144:147], v2, s[28:31], s54 offen sc1
    s_add_u32 s54, s77, 77824
    buffer_load_dwordx4 v[148:151], v2, s[28:31], s54 offen sc1
    s_add_u32 s54, s77, 81920
    buffer_load_dwordx4 v[152:155], v2, s[28:31], s54 offen sc1
    s_add_u32 s54, s77, 86016
    s_cmp_ge_u32 s49, 2
    s_cselect_b32 s54, 1073741824, s54
    buffer_load_dwordx4 v[156:159], v2, s[28:31], s54 offen sc1
    v_and_b32 v15, 31, v1
    v_lshlrev_b32 v15, 2, v15
    buffer_load_dword v24, v15, s[28:31], s86 offen sc1
Lhl_89:
Lpvd_45:
    s_waitcnt lgkmcnt(0)
    s_nop 7
    s_nop 3
    v_rcp_f32 v248, v240
    s_nop 0
    v_mul_f32 v232, v232, v248
    v_mul_f32 v233, v233, v248
    v_mul_f32 v234, v234, v248
    v_mul_f32 v235, v235, v248
    v_mul_f32 v236, v236, v248
    v_mul_f32 v237, v237, v248
    v_mul_f32 v238, v238, v248
    v_mul_f32 v239, v239, v248
    v_cvt_pk_bf16_f32 v248, v232, v233
    v_cvt_pk_bf16_f32 v249, v234, v235
    v_cvt_pk_bf16_f32 v250, v236, v237
    v_cvt_pk_bf16_f32 v251, v238, v239
    buffer_store_dwordx4 v[248:251], v2, s[28:31], s94 offen sc1
    s_cmp_lg_u32 s85, 0
    s_cbranch_scc1 Lhok_90
    s_mov_b32 s67, 0
Lpoll_91:
    buffer_load_dwordx4 v[252:255], v2, s[28:31], s100 offen sc1
    s_waitcnt vmcnt(0)
    v_xor_b32 v252, s58, v252
    v_xor_b32 v253, s59, v253
    v_xor_b32 v254, s58, v254
    v_xor_b32 v255, s59, v255
    v_or3_b32 v252, v252, v253, v254
    v_or_b32 v252, v252, v255
    v_cmp_ne_u32 vcc, 0, v252
    s_nop 3
    s_cmp_eq_u64 vcc, 0
    s_cbranch_scc1 Lpolld_92
    s_sleep 1
    s_add_u32 s67, s67, 1
    s_cmp_lt_u32 s67, 100000
    s_cbranch_scc1 Lpoll_91
Lpolld_92:
    s_add_u32 s54, s77, 0
    buffer_load_dwordx4 v[176:179], v2, s[28:31], s54 offen sc1
    s_add_u32 s54, s77, 4096
    buffer_load_dwordx4 v[180:183], v2, s[28:31], s54 offen sc1
    s_add_u32 s54, s77, 8192
    buffer_load_dwordx4 v[184:187], v2, s[28:31], s54 offen sc1
    s_add_u32 s54, s77, 12288
    buffer_load_dwordx4 v[188:191], v2, s[28:31], s54 offen sc1
    s_add_u32 s54, s77, 16384
    buffer_load_dwordx4 v[192:195], v2, s[28:31], s54 offen sc1
    s_add_u32 s54, s77, 20480
    buffer_load_dwordx4 v[196:199], v2, s[28:31], s54 offen sc1
    s_add_u32 s54, s77, 24576
    buffer_load_dwordx4 v[200:203], v2, s[28:31], s54 offen sc1
    s_add_u32 s54, s77, 28672
    buffer_load_dwordx4 v[204:207], v2, s[28:31], s54 offen sc1
    s_add_u32 s54, s77, 32768
    buffer_load_dwordx4 v[208:211], v2, s[28:31], s54 offen sc1
    s_add_u32 s54, s77, 36864
    buffer_load_dwordx4 v[212:215], v2, s[28:31], s54 offen sc1
    s_add_u32 s54, s77, 40960
    buffer_load_dwordx4 v[48:51], v2, s[28:31], s54 offen sc1
    s_add_u32 s54, s77, 45056
    buffer_load_dwordx4 v[52:55], v2, s[28:31], s54 offen sc1
    s_add_u32 s54, s77, 49152
    buffer_load_dwordx4 v[56:59], v2, s[28:31], s54 offen sc1
    s_add_u32 s54, s77, 53248
    buffer_load_dwordx4 v[60:63], v2, s[28:31], s54 offen sc1
    s_add_u32 s54, s77, 57344
    buffer_load_dwordx4 v[160:163], v2, s[28:31], s54 offen sc1
    s_add_u32 s54, s77, 61440
    buffer_load_dwordx4 v[164:167], v2, s[28:31], s54 offen sc1
    s_add_u32 s54, s77, 65536
    buffer_load_dwordx4 v[168:171], v2, s[28:31], s54 offen sc1
    s_add_u32 s54, s77, 69632
    buffer_load_dwordx4 v[172:175], v2, s[28:31], s54 offen sc1
    s_add_u32 s54, s77, 73728
    buffer_load_dwordx4 v[144:147], v2, s[28:31], s54 offen sc1
    s_add_u32 s54, s77, 77824
    buffer_load_dwordx4 v[148:151], v2, s[28:31], s54 offen sc1
    s_add_u32 s54, s77, 81920
    buffer_load_dwordx4 v[152:155], v2, s[28:31], s54 offen sc1
    s_add_u32 s54, s77, 86016
    s_cmp_ge_u32 s49, 2
    s_cselect_b32 s54, 1073741824, s54
    buffer_load_dwordx4 v[156:159], v2, s[28:31], s54 offen sc1
    v_and_b32 v15, 31, v1
    v_lshlrev_b32 v15, 2, v15
    buffer_load_dword v24, v15, s[28:31], s86 offen sc1
Lhok_90:
    ds_read_b64_tr_b16 v[64:65], v13 offset:0
    ds_read_b64_tr_b16 v[66:67], v13 offset:1024
    ds_read_b64_tr_b16 v[68:69], v31 offset:0
    ds_read_b64_tr_b16 v[70:71], v31 offset:1024
    ds_read_b64_tr_b16 v[72:73], v13 offset:8192
    ds_read_b64_tr_b16 v[74:75], v13 offset:9216
    ds_read_b64_tr_b16 v[76:77], v31 offset:8192
    ds_read_b64_tr_b16 v[78:79], v31 offset:9216
    s_waitcnt vmcnt(23)
    s_barrier
    ds_read_b64_tr_b16 v[80:81], v13 offset:16384
    ds_read_b64_tr_b16 v[82:83], v13 offset:17408
    s_waitcnt vmcnt(22)
    s_waitcnt lgkmcnt(8)
    v_mfma_f32_32x32x16_bf16 v[96:111], v[64:67], v[176:179], 0
    s_add_u32 s54, s65, 1048576
    s_add_u32 m0, s76, 65536
    s_nop 0
    buffer_load_dwordx4 v14, s[20:23], s54 offen lds
    ds_read_b64_tr_b16 v[84:85], v31 offset:16384
    ds_read_b64_tr_b16 v[86:87], v31 offset:17408
    s_waitcnt lgkmcnt(8)
    v_mfma_f32_32x32x16_bf16 v[112:127], v[68:71], v[176:179], 0
    s_add_u32 s54, s65, 1056768
    s_add_u32 m0, s76, 66560
    s_nop 0
    buffer_load_dwordx4 v14, s[20:23], s54 offen lds
    ds_read_b64_tr_b16 v[88:89], v13 offset:24576
    ds_read_b64_tr_b16 v[90:91], v13 offset:25600
    s_waitcnt vmcnt(23)
    s_waitcnt lgkmcnt(8)
    v_mfma_f32_32x32x16_bf16 v[96:111], v[72:75], v[180:183], v[96:111]
    s_add_u32 s54, s65, 1179648
    s_add_u32 m0, s76, 81920
    s_nop 0
    buffer_load_dwordx4 v14, s[20:23], s54 offen lds
    ds_read_b64_tr_b16 v[92:93], v31 offset:24576
    ds_read_b64_tr_b16 v[94:95], v31 offset:25600
    s_waitcnt lgkmcnt(8)
    v_mfma_f32_32x32x16_bf16 v[112:127], v[76:79], v[180:183], v[112:127]
    s_add_u32 s54, s65, 1187840
    s_add_u32 m0, s76, 82944
    s_nop 0
    buffer_load_dwordx4 v14, s[20:23], s54 offen lds
    ds_read_b64_tr_b16 v[64:65], v13 offset:32768
    ds_read_b64_tr_b16 v[66:67], v13 offset:33792
    s_waitcnt vmcnt(24)
    s_waitcnt lgkmcnt(8)
    v_mfma_f32_32x32x16_bf16 v[96:111], v[80:83], v[184:187], v[96:111]
    ds_read_b64_tr_b16 v[68:69], v31 offset:32768
    ds_read_b64_tr_b16 v[70:71], v31 offset:33792
    s_waitcnt lgkmcnt(8)
    v_mfma_f32_32x32x16_bf16 v[112:127], v[84:87], v[184:187], v[112:127]
    ds_read_b64_tr_b16 v[72:73], v13 offset:40960
    ds_read_b64_tr_b16 v[74:75], v13 offset:41984
    s_waitcnt vmcnt(23)
    s_waitcnt lgkmcnt(8)
    v_mfma_f32_32x32x16_bf16 v[96:111], v[88:91], v[188:191], v[96:111]
    ds_read_b64_tr_b16 v[76:77], v31 offset:40960
    ds_read_b64_tr_b16 v[78:79], v31 offset:41984
    s_waitcnt lgkmcnt(8)
    v_mfma_f32_32x32x16_bf16 v[112:127], v[92:95], v[188:191], v[112:127]
    ds_read_b64_tr_b16 v[80:81], v13 offset:49152
    ds_read_b64_tr_b16 v[82:83], v13 offset:50176
    s_waitcnt vmcnt(22)
    s_waitcnt lgkmcnt(8)
    v_mfma_f32_32x32x16_bf16 v[96:111], v[64:67], v[192:195], v[96:111]
    ds_read_b64_tr_b16 v[84:85], v31 offset:49152
    ds_read_b64_tr_b16 v[86:87], v31 offset:50176
    s_waitcnt lgkmcnt(8)
    v_mfma_f32_32x32x16_bf16 v[112:127], v[68:71], v[192:195], v[112:127]
    ds_read_b64_tr_b16 v[88:89], v13 offset:57344
    ds_read_b64_tr_b16 v[90:91], v13 offset:58368
    s_waitcnt vmcnt(21)
    s_waitcnt lgkmcnt(8)
    v_mfma_f32_32x32x16_bf16 v[96:111], v[72:75], v[196:199], v[96:111]
    ds_read_b64_tr_b16 v[92:93], v31 offset:57344
    ds_read_b64_tr_b16 v[94:95], v31 offset:58368
    s_waitcnt lgkmcnt(8)
    v_mfma_f32_32x32x16_bf16 v[112:127], v[76:79], v[196:199], v[112:127]
    s_barrier
    v_add_u32 v28, 131072, v13
    ds_read_b64_tr_b16 v[64:65], v28 offset:0
    ds_read_b64_tr_b16 v[66:67], v28 offset:1024
    s_waitcnt vmcnt(20)
    s_waitcnt lgkmcnt(8)
    v_mfma_f32_32x32x16_bf16 v[96:111], v[80:83], v[200:203], v[96:111]
    s_add_u32 s54, s65, 1310720
    s_add_u32 m0, s76, 0
    s_nop 0
    buffer_load_dwordx4 v14, s[20:23], s54 offen lds
    v_add_u32 v29, 131072, v31
    ds_read_b64_tr_b16 v[68:69], v29 offset:0
    ds_read_b64_tr_b16 v[70:71], v29 offset:1024
    s_waitcnt lgkmcnt(8)
    v_mfma_f32_32x32x16_bf16 v[112:127], v[84:87], v[200:203], v[112:127]
    s_add_u32 s54, s65, 1318912
    s_add_u32 m0, s76, 1024
    s_nop 0
    buffer_load_dwordx4 v14, s[20:23], s54 offen lds
    ds_read_b64_tr_b16 v[72:73], v28 offset:8192
    ds_read_b64_tr_b16 v[74:75], v28 offset:9216
    s_waitcnt vmcnt(21)
    s_waitcnt lgkmcnt(8)
    v_mfma_f32_32x32x16_bf16 v[96:111], v[88:91], v[204:207], v[96:111]
    s_add_u32 s54, s65, 0
    s_add_u32 m0, s76, 16384
    s_nop 0
    buffer_load_dwordx4 v14, s[24:27], s54 offen lds
    ds_read_b64_tr_b16 v[76:77], v29 offset:8192
    ds_read_b64_tr_b16 v[78:79], v29 offset:9216
    s_waitcnt lgkmcnt(8)
    v_mfma_f32_32x32x16_bf16 v[112:127], v[92:95], v[204:207], v[112:127]
    s_add_u32 s54, s65, 8192
    s_add_u32 m0, s76, 17408
    s_nop 0
    buffer_load_dwordx4 v14, s[24:27], s54 offen lds
    v_add_u32 v28, 147456, v13
    ds_read_b64_tr_b16 v[80:81], v28 offset:0
    ds_read_b64_tr_b16 v[82:83], v28 offset:1024
    s_waitcnt vmcnt(22)
    s_waitcnt lgkmcnt(8)
    v_mfma_f32_32x32x16_bf16 v[96:111], v[64:67], v[208:211], v[96:111]
    s_add_u32 s54, s65, 131072
    s_add_u32 m0, s76, 32768
    s_nop 0
    buffer_load_dwordx4 v14, s[24:27], s54 offen lds
    v_add_u32 v29, 147456, v31
    ds_read_b64_tr_b16 v[84:85], v29 offset:0
    ds_read_b64_tr_b16 v[86:87], v29 offset:1024
    s_waitcnt lgkmcnt(8)
    v_mfma_f32_32x32x16_bf16 v[112:127], v[68:71], v[208:211], v[112:127]
    s_add_u32 s54, s65, 139264
    s_add_u32 m0, s76, 33792
    s_nop 0
    buffer_load_dwordx4 v14, s[24:27], s54 offen lds
    ds_read_b64_tr_b16 v[88:89], v28 offset:8192
    ds_read_b64_tr_b16 v[90:91], v28 offset:9216
    s_waitcnt vmcnt(23)
    s_waitcnt lgkmcnt(8)
    v_mfma_f32_32x32x16_bf16 v[96:111], v[72:75], v[212:215], v[96:111]
    ds_read_b64_tr_b16 v[92:93], v29 offset:8192
    ds_read_b64_tr_b16 v[94:95], v29 offset:9216
    s_waitcnt lgkmcnt(8)
    v_mfma_f32_32x32x16_bf16 v[112:127], v[76:79], v[212:215], v[112:127]
    s_barrier
    v_add_u32 v28, 98304, v13
    ds_read_b64_tr_b16 v[64:65], v28 offset:0
    ds_read_b64_tr_b16 v[66:67], v28 offset:1024
    s_waitcnt vmcnt(22)
    s_waitcnt lgkmcnt(8)
    v_mfma_f32_32x32x16_bf16 v[96:111], v[80:83], v[48:51], v[96:111]
    s_add_u32 s54, s65, 262144
    s_add_u32 m0, s76, 49152
    s_nop 0
    buffer_load_dwordx4 v14, s[24:27], s54 offen lds
    v_add_u32 v29, 98304, v31
    ds_read_b64_tr_b16 v[68:69], v29 offset:0
    ds_read_b64_tr_b16 v[70:71], v29 offset:1024
    s_waitcnt lgkmcnt(8)
    v_mfma_f32_32x32x16_bf16 v[112:127], v[84:87], v[48:51], v[112:127]
    s_add_u32 s54, s65, 270336
    s_add_u32 m0, s76, 50176
    s_nop 0
    buffer_load_dwordx4 v14, s[24:27], s54 offen lds
    ds_read_b64_tr_b16 v[72:73], v28 offset:8192
    ds_read_b64_tr_b16 v[74:75], v28 offset:9216
    s_waitcnt vmcnt(23)
    s_waitcnt lgkmcnt(8)
    v_mfma_f32_32x32x16_bf16 v[96:111], v[88:91], v[52:55], v[96:111]
    s_add_u32 s54, s65, 393216
    s_add_u32 m0, s76, 131072
    s_nop 0
    buffer_load_dwordx4 v14, s[24:27], s54 offen lds
    ds_read_b64_tr_b16 v[76:77], v29 offset:8192
    ds_read_b64_tr_b16 v[78:79], v29 offset:9216
    s_waitcnt lgkmcnt(8)
    v_mfma_f32_32x32x16_bf16 v[112:127], v[92:95], v[52:55], v[112:127]
    s_add_u32 s54, s65, 401408
    s_add_u32 m0, s76, 132096
    s_nop 0
    buffer_load_dwordx4 v14, s[24:27], s54 offen lds
    v_add_u32 v28, 114688, v13
    ds_read_b64_tr_b16 v[80:81], v28 offset:0
    ds_read_b64_tr_b16 v[82:83], v28 offset:1024
    s_waitcnt vmcnt(24)
    s_waitcnt lgkmcnt(8)
    v_mfma_f32_32x32x16_bf16 v[96:111], v[64:67], v[56:59], v[96:111]
    s_add_u32 s54, s78, 0
    buffer_load_dwordx4 v[128:131], v2, s[28:31], s54 offen sc1
    v_add_u32 v29, 114688, v31
    ds_read_b64_tr_b16 v[84:85], v29 offset:0
    ds_read_b64_tr_b16 v[86:87], v29 offset:1024
    s_waitcnt lgkmcnt(8)
    v_mfma_f32_32x32x16_bf16 v[112:127], v[68:71], v[56:59], v[112:127]
    s_add_u32 s54, s78, 4096
    buffer_load_dwordx4 v[132:135], v2, s[28:31], s54 offen sc1
    ds_read_b64_tr_b16 v[88:89], v28 offset:8192
    ds_read_b64_tr_b16 v[90:91], v28 offset:9216
    s_waitcnt vmcnt(25)
    s_waitcnt lgkmcnt(8)
    v_mfma_f32_32x32x16_bf16 v[96:111], v[72:75], v[60:63], v[96:111]
    s_add_u32 s54, s78, 8192
    buffer_load_dwordx4 v[136:139], v2, s[28:31], s54 offen sc1
    ds_read_b64_tr_b16 v[92:93], v29 offset:8192
    ds_read_b64_tr_b16 v[94:95], v29 offset:9216
    s_waitcnt lgkmcnt(8)
    v_mfma_f32_32x32x16_bf16 v[112:127], v[76:79], v[60:63], v[112:127]
    s_add_u32 s54, s78, 12288
    buffer_load_dwordx4 v[140:143], v2, s[28:31], s54 offen sc1
    s_waitcnt vmcnt(14)
    s_barrier
    v_add_u32 v28, 65536, v13
    ds_read_b64_tr_b16 v[64:65], v28 offset:0
    ds_read_b64_tr_b16 v[66:67], v28 offset:1024
    s_waitcnt lgkmcnt(8)
    v_mfma_f32_32x32x16_bf16 v[96:111], v[80:83], v[160:163], v[96:111]
    s_add_u32 s54, s78, 16384
    buffer_load_dwordx4 v[32:35], v2, s[28:31], s54 offen sc1
    v_add_u32 v29, 65536, v31
    ds_read_b64_tr_b16 v[68:69], v29 offset:0
    ds_read_b64_tr_b16 v[70:71], v29 offset:1024
    s_waitcnt lgkmcnt(8)
    v_mfma_f32_32x32x16_bf16 v[112:127], v[84:87], v[160:163], v[112:127]
    s_add_u32 s54, s78, 20480
    buffer_load_dwordx4 v[36:39], v2, s[28:31], s54 offen sc1
    ds_read_b64_tr_b16 v[72:73], v28 offset:8192
    ds_read_b64_tr_b16 v[74:75], v28 offset:9216
    s_waitcnt lgkmcnt(8)
    v_mfma_f32_32x32x16_bf16 v[96:111], v[88:91], v[164:167], v[96:111]
    s_add_u32 s54, s78, 24576
    buffer_load_dwordx4 v[40:43], v2, s[28:31], s54 offen sc1
    ds_read_b64_tr_b16 v[76:77], v29 offset:8192
    ds_read_b64_tr_b16 v[78:79], v29 offset:9216
    s_waitcnt lgkmcnt(8)
    v_mfma_f32_32x32x16_bf16 v[112:127], v[92:95], v[164:167], v[112:127]
    s_add_u32 s54, s78, 28672
    buffer_load_dwordx4 v[44:47], v2, s[28:31], s54 offen sc1
    v_add_u32 v28, 81920, v13
    ds_read_b64_tr_b16 v[80:81], v28 offset:0
    ds_read_b64_tr_b16 v[82:83], v28 offset:1024
    s_waitcnt lgkmcnt(8)
    v_mfma_f32_32x32x16_bf16 v[96:111], v[64:67], v[168:171], v[96:111]
    v_add_u32 v29, 81920, v31
    ds_read_b64_tr_b16 v[84:85], v29 offset:0
    ds_read_b64_tr_b16 v[86:87], v29 offset:1024
    s_waitcnt lgkmcnt(8)
    v_mfma_f32_32x32x16_bf16 v[112:127], v[68:71], v[168:171], v[112:127]
    ds_read_b64_tr_b16 v[88:89], v28 offset:8192
    ds_read_b64_tr_b16 v[90:91], v28 offset:9216
    s_waitcnt lgkmcnt(8)
    v_mfma_f32_32x32x16_bf16 v[96:111], v[72:75], v[172:175], v[96:111]
    ds_read_b64_tr_b16 v[92:93], v29 offset:8192
    ds_read_b64_tr_b16 v[94:95], v29 offset:9216
    s_waitcnt lgkmcnt(8)
    v_mfma_f32_32x32x16_bf16 v[112:127], v[76:79], v[172:175], v[112:127]
    s_waitcnt vmcnt(12)
    s_barrier
    ds_read_b64_tr_b16 v[64:65], v13 offset:0
    ds_read_b64_tr_b16 v[66:67], v13 offset:1024
    s_waitcnt lgkmcnt(8)
    v_mfma_f32_32x32x16_bf16 v[96:111], v[80:83], v[144:147], v[96:111]
    ds_read_b64_tr_b16 v[68:69], v31 offset:0
    ds_read_b64_tr_b16 v[70:71], v31 offset:1024
    s_waitcnt lgkmcnt(8)
    v_mfma_f32_32x32x16_bf16 v[112:127], v[84:87], v[144:147], v[112:127]
    ds_read_b64_tr_b16 v[72:73], v13 offset:8192
    ds_read_b64_tr_b16 v[74:75], v13 offset:9216
    s_waitcnt lgkmcnt(8)
    v_mfma_f32_32x32x16_bf16 v[96:111], v[88:91], v[148:151], v[96:111]
    ds_read_b64_tr_b16 v[76:77], v31 offset:8192
    ds_read_b64_tr_b16 v[78:79], v31 offset:9216
    s_waitcnt lgkmcnt(8)
    v_mfma_f32_32x32x16_bf16 v[112:127], v[92:95], v[148:151], v[112:127]
    ds_read_b64_tr_b16 v[80:81], v13 offset:16384
    ds_read_b64_tr_b16 v[82:83], v13 offset:17408
    s_waitcnt lgkmcnt(8)
    v_mfma_f32_32x32x16_bf16 v[96:111], v[64:67], v[152:155], v[96:111]
    ds_read_b64_tr_b16 v[84:85], v31 offset:16384
    ds_read_b64_tr_b16 v[86:87], v31 offset:17408
    s_waitcnt lgkmcnt(8)
    v_mfma_f32_32x32x16_bf16 v[112:127], v[68:71], v[152:155], v[112:127]
    ds_read_b64_tr_b16 v[88:89], v13 offset:24576
    ds_read_b64_tr_b16 v[90:91], v13 offset:25600
    s_waitcnt lgkmcnt(8)
    v_mfma_f32_32x32x16_bf16 v[96:111], v[72:75], v[156:159], v[96:111]
    ds_read_b64_tr_b16 v[92:93], v31 offset:24576
    ds_read_b64_tr_b16 v[94:95], v31 offset:25600
    s_waitcnt lgkmcnt(8)
    v_mfma_f32_32x32x16_bf16 v[112:127], v[76:79], v[156:159], v[112:127]
    ds_read_b64_tr_b16 v[64:65], v13 offset:32768
    ds_read_b64_tr_b16 v[66:67], v13 offset:33792
    s_waitcnt vmcnt(0)
    s_mov_b32 s67, 0
Lop_93:
    v_max3_u32 v18, v128, v129, v130
    v_max3_u32 v18, v131, v132, v18
    v_max3_u32 v18, v133, v134, v18
    v_max3_u32 v18, v135, v136, v18
    v_max3_u32 v18, v137, v138, v18
    v_max3_u32 v18, v139, v140, v18
    v_max3_u32 v18, v141, v142, v18
    v_max3_u32 v18, v143, v32, v18
    v_max3_u32 v18, v33, v34, v18
    v_max3_u32 v18, v35, v36, v18
    v_max3_u32 v18, v37, v38, v18
    v_max3_u32 v18, v39, v40, v18
    v_max3_u32 v18, v41, v42, v18
    v_max3_u32 v18, v43, v44, v18
    v_max3_u32 v18, v45, v46, v18
    v_max_u32 v18, v47, v18
    v_cmp_eq_u32 vcc, -1, v18
    s_nop 3
    s_cmp_eq_u64 vcc, 0
    s_cbranch_scc1 Lod_94
    s_add_u32 s54, s78, 0
    buffer_load_dwordx4 v[128:131], v2, s[28:31], s54 offen sc1
    s_add_u32 s54, s78, 4096
    buffer_load_dwordx4 v[132:135], v2, s[28:31], s54 offen sc1
    s_add_u32 s54, s78, 8192
    buffer_load_dwordx4 v[136:139], v2, s[28:31], s54 offen sc1
    s_add_u32 s54, s78, 12288
    buffer_load_dwordx4 v[140:143], v2, s[28:31], s54 offen sc1
    s_add_u32 s54, s78, 16384
    buffer_load_dwordx4 v[32:35], v2, s[28:31], s54 offen sc1
    s_add_u32 s54, s78, 20480
    buffer_load_dwordx4 v[36:39], v2, s[28:31], s54 offen sc1
    s_add_u32 s54, s78, 24576
    buffer_load_dwordx4 v[40:43], v2, s[28:31], s54 offen sc1
    s_add_u32 s54, s78, 28672
    buffer_load_dwordx4 v[44:47], v2, s[28:31], s54 offen sc1
    s_waitcnt vmcnt(0)
    s_add_u32 s67, s67, 1
    s_cmp_lt_u32 s67, 100000
    s_cbranch_scc1 Lop_93
Lod_94:
    s_waitcnt lgkmcnt(8)
    v_mfma_f32_32x32x16_bf16 v[216:231], v[80:83], v[128:131], 0
    v_sub_f32 v20, 1.0, v24
    v_cvt_pk_bf16_f32 v20, v20, v20
    v_lshlrev_b32 v20, 16, v20
    v_mov_b32 v21, v20
    v_mov_b32 v25, v24
    ds_read_b64_tr_b16 v[68:69], v31 offset:32768
    ds_read_b64_tr_b16 v[70:71], v31 offset:33792
    s_waitcnt lgkmcnt(8)
    v_mfma_f32_32x32x16_bf16 v[232:247], v[84:87], v[128:131], 0
    ds_read_b64_tr_b16 v[72:73], v13 offset:40960
    ds_read_b64_tr_b16 v[74:75], v13 offset:41984
    s_waitcnt lgkmcnt(8)
    v_mfma_f32_32x32x16_bf16 v[216:231], v[88:91], v[132:135], v[216:231]
    v_pk_mul_f32 v[96:97], v[96:97], v[20:21]
    v_pk_mul_f32 v[98:99], v[98:99], v[20:21]
    ds_read_b64_tr_b16 v[76:77], v31 offset:40960
    ds_read_b64_tr_b16 v[78:79], v31 offset:41984
    s_waitcnt lgkmcnt(8)
    v_mfma_f32_32x32x16_bf16 v[232:247], v[92:95], v[132:135], v[232:247]
    v_pk_mul_f32 v[100:101], v[100:101], v[20:21]
    v_pk_mul_f32 v[102:103], v[102:103], v[20:21]
    s_barrier
    ds_read_b64_tr_b16 v[80:81], v13 offset:49152
    ds_read_b64_tr_b16 v[82:83], v13 offset:50176
    s_waitcnt lgkmcnt(8)
    v_mfma_f32_32x32x16_bf16 v[216:231], v[64:67], v[136:139], v[216:231]
    v_pk_mul_f32 v[104:105], v[104:105], v[20:21]
    v_pk_mul_f32 v[106:107], v[106:107], v[20:21]
    ds_read_b64_tr_b16 v[84:85], v31 offset:49152
    ds_read_b64_tr_b16 v[86:87], v31 offset:50176
    s_waitcnt lgkmcnt(8)
    v_mfma_f32_32x32x16_bf16 v[232:247], v[68:71], v[136:139], v[232:247]
    v_pk_mul_f32 v[108:109], v[108:109], v[20:21]
    v_pk_mul_f32 v[110:111], v[110:111], v[20:21]
    ds_read_b64_tr_b16 v[88:89], v13 offset:57344
    ds_read_b64_tr_b16 v[90:91], v13 offset:58368
    s_waitcnt lgkmcnt(8)
    v_mfma_f32_32x32x16_bf16 v[216:231], v[72:75], v[140:143], v[216:231]
    v_pk_mul_f32 v[112:113], v[112:113], v[20:21]
    v_pk_mul_f32 v[114:115], v[114:115], v[20:21]
    ds_read_b64_tr_b16 v[92:93], v31 offset:57344
    ds_read_b64_tr_b16 v[94:95], v31 offset:58368
    s_waitcnt lgkmcnt(8)
    v_mfma_f32_32x32x16_bf16 v[232:247], v[76:79], v[140:143], v[232:247]
    v_pk_mul_f32 v[116:117], v[116:117], v[20:21]
    v_pk_mul_f32 v[118:119], v[118:119], v[20:21]
    v_add_u32 v28, 131072, v13
    ds_read_b64_tr_b16 v[64:65], v28 offset:0
    ds_read_b64_tr_b16 v[66:67], v28 offset:1024
    s_waitcnt lgkmcnt(8)
    v_mfma_f32_32x32x16_bf16 v[216:231], v[80:83], v[32:35], v[216:231]
    v_pk_mul_f32 v[120:121], v[120:121], v[20:21]
    v_pk_mul_f32 v[122:123], v[122:123], v[20:21]
    v_add_u32 v29, 131072, v31
    ds_read_b64_tr_b16 v[68:69], v29 offset:0
    ds_read_b64_tr_b16 v[70:71], v29 offset:1024
    s_waitcnt lgkmcnt(8)
    v_mfma_f32_32x32x16_bf16 v[232:247], v[84:87], v[32:35], v[232:247]
    v_pk_mul_f32 v[124:125], v[124:125], v[20:21]
    v_pk_mul_f32 v[126:127], v[126:127], v[20:21]
    ds_read_b64_tr_b16 v[72:73], v28 offset:8192
    ds_read_b64_tr_b16 v[74:75], v28 offset:9216
    s_waitcnt lgkmcnt(8)
    v_mfma_f32_32x32x16_bf16 v[216:231], v[88:91], v[36:39], v[216:231]
    ds_read_b64_tr_b16 v[76:77], v29 offset:8192
    ds_read_b64_tr_b16 v[78:79], v29 offset:9216
    s_waitcnt lgkmcnt(8)
    v_mfma_f32_32x32x16_bf16 v[232:247], v[92:95], v[36:39], v[232:247]
    s_waitcnt lgkmcnt(6)
    v_mfma_f32_32x32x16_bf16 v[216:231], v[64:67], v[40:43], v[216:231]
    s_waitcnt lgkmcnt(4)
    v_mfma_f32_32x32x16_bf16 v[232:247], v[68:71], v[40:43], v[232:247]
    s_waitcnt lgkmcnt(2)
    v_mfma_f32_32x32x16_bf16 v[216:231], v[72:75], v[44:47], v[216:231]
    s_waitcnt lgkmcnt(0)
    v_mfma_f32_32x32x16_bf16 v[232:247], v[76:79], v[44:47], v[232:247]
    s_cmp_eq_u32 s49, 1
    s_movk_i32 s54, 9
    s_cselect_b32 s54, 6, s54
    s_cmp_eq_u32 s49, 2
    s_cselect_b32 s54, 7, s54
    s_cmp_eq_u32 s49, 3
    s_cselect_b32 s54, 4, s54
    s_lshl_b32 s54, s54, 14
    s_lshl_b32 s55, s50, 13
    s_add_u32 s54, s54, s55
    v_and_b32 v15, 31, v1
    v_and_b32 v16, 7, v1
    v_xor_b32 v16, v16, v17
    v_lshlrev_b32 v16, 4, v16
    v_lshl_add_u32 v15, v15, 8, v16
    v_add_u32 v15, s54, v15
    s_nop 4
    v_pk_fma_f32 v[96:97], v[216:217], v[24:25], v[96:97]
    v_pk_fma_f32 v[98:99], v[218:219], v[24:25], v[98:99]
    v_xor_b32 v18, 0, v15
    ds_write_b128 v18, v[96:99] offset:0
    v_pk_fma_f32 v[100:101], v[220:221], v[24:25], v[100:101]
    v_pk_fma_f32 v[102:103], v[222:223], v[24:25], v[102:103]
    v_xor_b32 v19, 32, v15
    ds_write_b128 v19, v[100:103] offset:0
    v_pk_fma_f32 v[104:105], v[224:225], v[24:25], v[104:105]
    v_pk_fma_f32 v[106:107], v[226:227], v[24:25], v[106:107]
    v_xor_b32 v18, 64, v15
    ds_write_b128 v18, v[104:107] offset:0
    v_pk_fma_f32 v[108:109], v[228:229], v[24:25], v[108:109]
    v_pk_fma_f32 v[110:111], v[230:231], v[24:25], v[110:111]
    v_xor_b32 v19, 96, v15
    ds_write_b128 v19, v[108:111] offset:0
    v_pk_fma_f32 v[112:113], v[232:233], v[24:25], v[112:113]
    v_pk_fma_f32 v[114:115], v[234:235], v[24:25], v[114:115]
    v_xor_b32 v18, 0, v15
    ds_write_b128 v18, v[112:115] offset:128
    v_pk_fma_f32 v[116:117], v[236:237], v[24:25], v[116:117]
    v_pk_fma_f32 v[118:119], v[238:239], v[24:25], v[118:119]
    v_xor_b32 v19, 32, v15
    ds_write_b128 v19, v[116:119] offset:128
    v_pk_fma_f32 v[120:121], v[240:241], v[24:25], v[120:121]
    v_pk_fma_f32 v[122:123], v[242:243], v[24:25], v[122:123]
    v_xor_b32 v18, 64, v15
    ds_write_b128 v18, v[120:123] offset:128
    v_pk_fma_f32 v[124:125], v[244:245], v[24:25], v[124:125]
    v_pk_fma_f32 v[126:127], v[246:247], v[24:25], v[126:127]
    v_xor_b32 v19, 96, v15
    ds_write_b128 v19, v[124:127] offset:128
    v_lshrrev_b32 v15, 3, v0
    v_and_b32 v16, 7, v0
    v_and_b32 v18, 7, v15
    v_lshlrev_b32 v19, 1, v16
    v_xor_b32 v18, v18, v19
    v_lshlrev_b32 v18, 4, v18
    v_lshl_add_u32 v18, v15, 8, v18
    v_xor_b32 v19, 16, v18
    v_add_u32 v28, 0x10000, v18
    v_add_u32 v29, 0x10000, v19
    v_add_u32 v11, 0x20000, v18
    v_add_u32 v12, 0x20000, v19
    v_lshlrev_b32 v15, 10, v15
    v_lshl_add_u32 v15, v16, 4, v15
    s_lshl_b32 s54, s51, 16
    s_lshl_b32 s55, s52, 7
    s_add_u32 s54, s54, s55
    s_waitcnt lgkmcnt(0)
    s_barrier
    ds_read_b128 v[64:67], v11 offset:16384
    ds_read_b128 v[68:71], v12 offset:16384
    ds_read_b128 v[72:75], v28 offset:32768
    ds_read_b128 v[76:79], v29 offset:32768
    ds_read_b128 v[80:83], v28 offset:49152
    ds_read_b128 v[84:87], v29 offset:49152
    ds_read_b128 v[88:91], v28 offset:0
    ds_read_b128 v[92:95], v29 offset:0
    s_waitcnt lgkmcnt(4)
    v_pk_add_f32 v[64:65], v[64:65], v[72:73]
    v_pk_add_f32 v[66:67], v[66:67], v[74:75]
    v_pk_add_f32 v[68:69], v[68:69], v[76:77]
    v_pk_add_f32 v[70:71], v[70:71], v[78:79]
    s_waitcnt lgkmcnt(0)
    v_pk_add_f32 v[80:81], v[80:81], v[88:89]
    v_pk_add_f32 v[82:83], v[82:83], v[90:91]
    v_pk_add_f32 v[84:85], v[84:85], v[92:93]
    v_pk_add_f32 v[86:87], v[86:87], v[94:95]
    v_pk_add_f32 v[64:65], v[64:65], v[80:81]
    v_pk_add_f32 v[66:67], v[66:67], v[82:83]
    v_pk_add_f32 v[68:69], v[68:69], v[84:85]
    v_pk_add_f32 v[70:71], v[70:71], v[86:87]
    v_cvt_pk_bf16_f32 v64, v64, v65
    v_cvt_pk_bf16_f32 v65, v66, v67
    v_cvt_pk_bf16_f32 v66, v68, v69
    v_cvt_pk_bf16_f32 v67, v70, v71
    buffer_store_dwordx4 v[64:67], v15, s[32:35], s54 offen sc1
L_exit:
    s_endpgm
.section .rodata,"a"
.p2align 6
.amdhsa_kernel gated_mix__sliding_block__dense_activation_relu__prompt_kernel
  .amdhsa_next_free_vgpr 256
  .amdhsa_next_free_sgpr 102
  .amdhsa_accum_offset 256
  .amdhsa_group_segment_fixed_size 0
  .amdhsa_kernarg_size 80
  .amdhsa_user_sgpr_count 2
  .amdhsa_user_sgpr_kernarg_segment_ptr 1
  .amdhsa_system_sgpr_workgroup_id_x 1
.end_amdhsa_kernel
```
